```python
import torch

def _softmax(x, axis=-1):
    return torch.softmax(x, dim=axis)
def _gelu(x):
    return torch.nn.functional.gelu(x, approximate="tanh")
def _silu(x):
    return torch.nn.functional.silu(x)
def _sigmoid(x):
    return torch.sigmoid(x)
def _layernorm(x, axis=-1, eps=1e-5):
    m = x.mean(dim=axis, keepdim=True)
    v = x.var(dim=axis, keepdim=True, unbiased=False)
    return (x - m) / torch.sqrt(v + eps)
def _scatter_add(tgt, idx, src, axis=0):
    return tgt.clone().index_add_(axis, idx, src)
def _segment_sum(src, seg, n):
    out = torch.zeros((n,) + src.shape[1:], dtype=src.dtype)
    return out.index_add_(0, seg, src)
def _pad(x, pw):
    flat = tuple(v for pair in reversed(pw) for v in pair)
    return torch.nn.functional.pad(x, flat)

kernel_name = 'standalone__cheap_equivariant_egnn__graph'

def setup_inputs():

    _w = (lambda a: (lambda t: t.to(torch.bfloat16) if t.is_floating_point() else t)(torch.as_tensor(a)))
    N, deg, D, De = 10000, 64, 64, max(16, 1)
    E = N * deg
    return {
        "h": _w((lambda *s: torch.randn(*s, dtype=torch.bfloat16) * 0.1)(N, D)),
        "pos": _w((lambda *s: torch.randn(*s, dtype=torch.bfloat16) * 0.8)(N, 3)),
        "e_attr": _w((lambda *s: torch.randn(*s, dtype=torch.bfloat16) * 0.8)(E, De)),
        "src": _w((lambda lo, hi, *s: torch.randint(lo, hi, s))(0, N, E).to(torch.int64)),
        "dst": _w((lambda lo, hi, *s: torch.randint(lo, hi, s))(0, N, E).to(torch.int64)),
        "w_e": _w(0.1 * (lambda *s: torch.randn(*s, dtype=torch.bfloat16) * 0.8)(2 * D + 1 + De, D)),
        "w_x": _w(0.1 * (lambda *s: torch.randn(*s, dtype=torch.bfloat16) * 0.1)(D, 1)),
        "w_h": _w(0.1 * (lambda *s: torch.randn(*s, dtype=torch.bfloat16) * 0.1)(2 * D, D)),
    }

def reference(h, pos, e_attr, src, dst, w_e, w_x, w_h):
    N, D = h.shape[0], h.shape[1]
    diff = pos[dst] - pos[src]
    dist2 = torch.sum(diff * diff, axis=-1, keepdims=True)
    e_in = torch.concatenate([h[dst], h[src], dist2, e_attr], axis=-1)
    m_ij = _silu(e_in @ w_e)
    coord_scale = m_ij @ w_x
    pos_new = pos + _segment_sum(diff * coord_scale, dst, N)
    m_i = _segment_sum(m_ij, dst, N)
    h_new = h + _silu(torch.concatenate([h, m_i], axis=-1) @ w_h)
    return h_new, pos_new
```

```asm
; @launch grid=(256,1,1) block=(512,1,1) lds=163072
.amdgcn_target "amdgcn-amd-amdhsa--gfx950"
.text
.globl standalone__cheap_equivariant_egnn__graph_kernel
.p2align 8
.type standalone__cheap_equivariant_egnn__graph_kernel,@function
standalone__cheap_equivariant_egnn__graph_kernel:
    s_cmp_ge_u32 s2, 256
    s_cbranch_scc1 L_done
    s_load_dwordx16 s[4:19], s[0:1], 0
    s_load_dwordx4 s[20:23], s[0:1], 64
    s_load_dwordx2 s[24:25], s[0:1], 80
    v_lshrrev_b32 v3, 6, v0
    v_and_b32 v1, 63, v0
    v_readfirstlane_b32 s26, v3
    s_setprio 1
    s_cmp_lt_u32 s26, 7
    s_cbranch_scc1 L_back1
    s_lshr_b32 s3, s2, 3
    s_and_b32 s3, s3, 15
    s_cmp_eq_u32 s3, 0
    s_cbranch_scc1 L_st_sh
    s_cmp_eq_u32 s3, 1
    s_cbranch_scc1 L_st_b1
    s_cmp_eq_u32 s3, 2
    s_cbranch_scc1 L_st_y1
    s_cmp_eq_u32 s3, 3
    s_cbranch_scc1 L_st_y2
    s_cmp_eq_u32 s3, 4
    s_cbranch_scc1 L_st_p2
    s_cmp_eq_u32 s3, 5
    s_cbranch_scc1 L_st_b3
    s_cmp_eq_u32 s3, 6
    s_cbranch_scc1 L_st_poll
    s_cmp_eq_u32 s3, 7
    s_cbranch_scc1 L_st_w0
    s_cmp_eq_u32 s3, 8
    s_cbranch_scc1 L_st_c
    s_cmp_eq_u32 s3, 9
    s_cbranch_scc1 L_st_p3
    s_cmp_eq_u32 s3, 10
    s_cbranch_scc1 L_st_b5
    s_cmp_eq_u32 s3, 11
    s_cbranch_scc1 L_st_tile
    s_cmp_eq_u32 s3, 12
    s_cbranch_scc1 L_st_odd
    s_cmp_eq_u32 s3, 13
    s_cbranch_scc1 L_st_last
    s_cmp_eq_u32 s3, 14
    s_cbranch_scc1 L_st_l2
    s_cmp_eq_u32 s3, 15
    s_cbranch_scc1 L_st_epi
L_back1:
    s_mul_i32 s3, s2, 10000
    v_lshl_add_u32 v116, v0, 4, s3
    s_add_u32 s3, s3, 8192
    v_lshl_add_u32 v117, v0, 2, s3
    v_cmp_gt_u32 vcc, 452, v0
    v_lshrrev_b32 v2, 5, v1
    s_mul_i32 s64, s2, 5000
    s_add_u32 s94, s64, 127
    s_lshr_b32 s94, s94, 7
    s_mov_b64 s[58:59], vcc
    s_lshl_b32 s93, s26, 10
    s_mov_b32 s65, 8486912
    v_mov_b32 v156, 0
    v_mov_b32 v157, 0
    v_mov_b32 v158, 0
    v_mov_b32 v159, 0
    v_lshlrev_b32 v125, 4, v0
    v_lshrrev_b32 v224, 3, v0
    v_mul_u32_u24 v248, 160000, v224
    v_add_u32 v224, s94, v224
    v_and_b32 v225, 0x70, v125
    v_and_b32 v161, 31, v1
    s_mul_i32 s81, s26, 3328
    s_add_u32 s81, s81, 136448
    v_and_b32 v234, 16, v1
    v_lshlrev_b32 v233, 2, v234
    v_xor_b32 v124, v125, v233
    s_add_u32 m0, s93, 49664
    s_movk_i32 s67, 8192
    s_mov_b32 s42, 18560
    s_mov_b32 s43, 0x20000
    s_mov_b32 s30, 10000
    s_mov_b32 s31, 0x20000
    s_mul_i32 s66, s26, 3344
    s_waitcnt lgkmcnt(0)
    s_mov_b64 s[40:41], s[14:15]
    s_mov_b32 s28, s4
    s_cmp_gt_u32 s26, 6
    s_cbranch_scc1 L_w2done
    buffer_load_dwordx4 v124, s[40:43], s67 offen lds
    s_cmp_lt_u32 s26, 6
    s_cbranch_scc1 L_w2done
    buffer_load_dwordx4 v124, s[40:43], s67 offen offset:1024 lds
L_w2done:
    s_add_u32 m0, s66, 136960
    s_and_b32 s29, s5, 0xffff
    s_or_b32 s29, s29, 0x800000
    s_load_dword s89, s[24:25], s65
    s_cmp_ge_u32 s26, 5
    s_cbranch_scc1 L_share
    buffer_load_dwordx4 v[224:225], s[28:31], 0 idxen offen lds
    s_branch L_share_done
L_st_sh:
    s_branch L_back1
L_share:
    s_lshr_b32 s64, s2, 3
    s_mov_b32 s40, s6
    s_mov_b32 s41, s7
    s_mov_b32 s42, 60000
    s_mov_b32 s43, 0x20000
    s_mov_b32 s66, 15
    s_cmp_eq_u32 s26, 6
    s_cselect_b64 s[40:41], s[14:15], s[40:41]
    s_cselect_b32 s42, 18560, s42
    s_cselect_b32 s66, 5, s66
    s_cmp_eq_u32 s26, 7
    s_cselect_b64 s[40:41], s[18:19], s[40:41]
    s_cselect_b32 s42, 16384, s42
    s_cselect_b32 s66, 4, s66
    s_mul_i32 s64, s64, s66
    v_add_lshl_u32 v233, v1, s64, 7
    s_bfm_b64 exec, s66, 0
    buffer_load_dword v247, v233, s[40:43], 0 offen
    s_mov_b64 exec, -1
L_share_done:
    ds_write_b128 v125, v[156:159] offset:512
    ds_write_b128 v125, v[156:159] offset:8704
    ds_write_b128 v125, v[156:159] offset:16896
    ds_write_b128 v125, v[156:159] offset:25088
    ds_write_b128 v125, v[156:159] offset:33280
    global_load_dwordx4 v[84:87], v116, s[12:13]
    s_mov_b64 exec, s[58:59]
    global_load_dword v88, v117, s[12:13]
    s_mov_b64 exec, -1
    v_mfma_f32_16x16x4_4b_bf16 v[208:223], v[156:157], v[156:157], 0
    v_mfma_f32_16x16x4_4b_bf16 v[164:179], v[156:157], v[156:157], 0
    s_add_u32 s28, s24, 16777216
    s_addc_u32 s29, s25, 0
    s_and_b32 s29, s29, 0xffff
    s_or_b32 s29, s29, 0x800000
    v_mov_b32 v228, 0xffffffc6
    v_mov_b32 v229, 10000
    v_lshl_add_u32 v231, v1, 3, s81
    ds_write_b64 v231, v[228:229]
    s_cmp_lg_u32 s26, 0
    s_cbranch_scc1 L_init_done
    v_lshrrev_b32 v231, 1, v1
    v_mul_u32_u24 v231, 3328, v231
    v_add_u32 v231, 136448, v231
    v_mov_b32 v232, 0x3f80
    s_mov_b64 s[66:67], 0xffff
    v_cndmask_b32 v231, 0, v231, s[66:67]
    s_mov_b32 s66, 0
    s_mov_b32 s67, 0x402010
    v_cndmask_b32 v231, v231, v232, s[66:67]
    s_mov_b32 s67, 0x20100
    v_cndmask_b32 v231, v231, 1.0, s[66:67]
    v_lshlrev_b32 v232, 2, v1
    ds_write_b32 v232, v231
L_init_done:
    v_mov_b32 v160, 4
    v_lshlrev_b32 v148, 8, v0
    v_add_u32 v149, 64, v148
    v_add_u32 v150, 128, v148
    v_add_u32 v151, 192, v148
    v_lshlrev_b32 v152, 6, v0
    v_add_u32 v152, 131072, v152
    v_and_b32 v231, 3, v1
    v_lshlrev_b32 v231, 3, v231
    v_lshl_add_u32 v207, v234, 1, v231
    v_and_b32 v232, 12, v1
    v_lshl_add_u32 v231, v232, 5, v207
    v_lshl_add_u32 v207, v232, 4, v207
    v_and_b32 v232, 8, v1
    v_lshl_add_u32 v243, v232, 3, v231
    v_lshl_add_u32 v231, v2, 10, v243
    v_add_u32 v3, 41472, v231
    s_bfe_u32 s64, s26, 0x10001
    s_mul_i32 s64, s64, 20
    v_add_u32 v129, s64, v161
    v_lshrrev_b32 v232, 3, v129
    v_mul_u32_u24 v232, 2320, v232
    v_lshl_add_u32 v127, v129, 7, v232
    v_lshl_add_u32 v127, v2, 4, v127
    v_add_u32 v127, 136960, v127
    s_and_b32 s65, s26, 1
    s_lshr_b32 s66, s26, 2
    s_lshl_b32 s64, s65, 6
    s_mul_i32 s67, s66, 18560
    v_xor_b32 v128, s64, v3
    v_add_u32 v128, s67, v128
    s_lshl_b32 s64, s2, 3
    s_add_u32 s64, s64, s26
    s_mul_i32 s64, s64, 625
    s_add_u32 s27, s64, 127
    s_lshr_b32 s27, s27, 7
    s_add_u32 s88, s64, 752
    s_lshr_b32 s88, s88, 7
    s_sub_u32 s88, s88, s27
    s_movk_i32 s65, 120
    s_movk_i32 s67, 8192
    global_load_dwordx4 v[92:95], v116, s[10:11]
    s_mov_b64 exec, s[58:59]
    global_load_dword v96, v117, s[10:11]
    s_mov_b64 exec, -1
    s_mov_b32 s36, s24
    s_mov_b32 s37, s25
    s_mov_b32 s38, 8486912
    s_mov_b32 s39, 0x20000
    s_mov_b32 s40, s14
    s_mov_b32 s41, s15
    s_mov_b32 s42, 18560
    s_mov_b32 s43, 0x20000
    s_mov_b32 s44, s18
    s_mov_b32 s45, s19
    s_mov_b32 s46, 16384
    s_mov_b32 s47, 0x20000
    v_lshrrev_b32 v232, 3, v0
    v_and_b32 v231, 0x70, v125
    v_mul_u32_u24 v120, 33152, v232
    s_lshl_b32 s68, s2, 7
    v_add3_u32 v120, v120, v231, s68
    v_add_u32 v121, 2121728, v120
    v_lshrrev_b32 v232, 1, v1
    v_and_b32 v232, 28, v232
    v_and_b32 v119, 4, v1
    v_lshl_add_u32 v119, v119, 3, v232
    v_lshl_add_u32 v119, s26, 6, v119
    v_and_b32 v231, 48, v125
    v_mad_u32_u24 v118, v119, 36, v231
    v_add_u32 v126, 49664, v125
    s_lshl_b32 s68, s26, 11
    s_add_u32 s68, s68, 41472
    s_sub_u32 s69, s68, 8
    v_lshl_add_u32 v207, v2, 8, v207
    v_add_u32 v207, s68, v207
    v_lshl_add_u32 v206, v161, 6, s69
    v_lshl_add_u32 v137, v1, 3, s68
    v_lshl_add_u32 v243, v2, 9, v243
    v_add_u32 v243, 68224, v243
    v_xor_b32 v136, 64, v3
    s_lshr_b32 s68, s26, 2
    s_mul_i32 s68, s68, 10880
    s_and_b32 s69, s26, 1
    s_lshl_b32 s69, s69, 7
    s_add_u32 s68, s68, s69
    s_add_u32 s68, s68, 512
    v_mul_u32_u24 v129, 272, v129
    v_lshl_add_u32 v129, v2, 4, v129
    v_add_u32 v129, s68, v129
    s_sub_u32 s68, s27, s94
    s_mul_i32 s69, s68, 272
    s_add_u32 s69, s69, 512
    v_lshl_add_u32 v130, v161, 2, s69
    v_mul_u32_u24 v131, 272, v2
    v_add_u32 v131, v131, v130
    v_lshlrev_b32 v233, 1, v161
    v_add_u32 v135, 59904, v233
    v_add_u32 v233, 136960, v233
    v_add_u32 v231, s68, v2
    s_movk_i32 s68, 2320
    v_lshrrev_b32 v232, 3, v231
    v_lshl_add_u32 v132, v231, 7, v233
    v_mad_u32_u24 v132, v232, s68, v132
    v_add_u32 v231, 2, v231
    v_lshrrev_b32 v232, 3, v231
    v_lshl_add_u32 v133, v231, 7, v233
    v_mad_u32_u24 v133, v232, s68, v133
    v_add_u32 v231, 2, v231
    v_lshrrev_b32 v232, 3, v231
    v_lshl_add_u32 v134, v231, 7, v233
    v_mad_u32_u24 v134, v232, s68, v134
    s_cmp_eq_u32 s26, 1
    s_cbranch_scc1 L_lt_p2
L_back3:
    s_branch L_sk_b1
L_st_b1:
    s_branch L_back1
L_sk_b1:
    s_cmp_ge_u32 s26, 5
    s_waitcnt vmcnt(5) lgkmcnt(0)
    s_cbranch_scc1 L_b1
    s_waitcnt vmcnt(4)
L_b1:
    s_barrier
    s_and_b32 s89, s89, -8
    s_cmp_ge_u32 s26, 4
    s_cbranch_scc1 L_y1
    ds_read_b128 v[4:7], v127 offset:0
    ds_read_b64_tr_b16 v[20:21], v128 offset:8192
    ds_read_b64_tr_b16 v[22:23], v128 offset:8704
    ds_read_b128 v[8:11], v127 offset:32
    ds_read_b64_tr_b16 v[24:25], v128 offset:10240
    ds_read_b64_tr_b16 v[26:27], v128 offset:10752
    ds_read_b128 v[12:15], v127 offset:64
    ds_read_b64_tr_b16 v[28:29], v128 offset:12288
    ds_read_b64_tr_b16 v[30:31], v128 offset:12800
    ds_read_b128 v[16:19], v127 offset:96
    ds_read_b64_tr_b16 v[32:33], v128 offset:14336
    ds_read_b64_tr_b16 v[34:35], v128 offset:14848
    s_add_u32 s68, s81, 1664
    v_mul_u32_u24 v140, 80, v161
    v_lshl_add_u32 v140, v2, 5, v140
    v_add_u32 v140, s68, v140
    v_lshrrev_b32 v231, 2, v1
    v_and_b32 v232, 48, v125
    v_mul_u32_u24 v141, 80, v231
    v_add3_u32 v141, v141, v232, s68
    s_bfe_u32 s68, s26, 0x10001
    s_mul_i32 s68, s68, 20
    s_add_u32 s68, s68, s94
    v_add_u32 v142, s68, v231
    s_and_b32 s68, s26, 1
    s_lshl_b32 s68, s68, 6
    v_add_u32 v143, s68, v232
    s_waitcnt lgkmcnt(9)
    v_mfma_f32_32x32x16_bf16 v[52:67], v[20:23], v[4:7], 0
    s_waitcnt lgkmcnt(6)
    v_mfma_f32_32x32x16_bf16 v[52:67], v[24:27], v[8:11], v[52:67]
    s_waitcnt lgkmcnt(3)
    v_mfma_f32_32x32x16_bf16 v[52:67], v[28:31], v[12:15], v[52:67]
    s_waitcnt lgkmcnt(0)
    v_mfma_f32_32x32x16_bf16 v[52:67], v[32:35], v[16:19], v[52:67]
    s_add_u32 s76, s89, 0x9e3779b8
    s_mul_i32 s76, s76, 0x85ebca6b
    s_lshr_b32 s3, s76, 15
    s_xor_b32 s76, s76, s3
    s_mul_i32 s76, s76, 0xc2b2ae35
    s_and_b32 s76, s76, -16
    s_or_b32 s76, s76, 1
    s_add_u32 s77, s89, 0x9e3779b9
    s_mul_i32 s77, s77, 0x85ebca6b
    s_lshr_b32 s3, s77, 15
    s_xor_b32 s77, s77, s3
    s_mul_i32 s77, s77, 0xc2b2ae35
    s_and_b32 s77, s77, -16
    s_or_b32 s77, s77, 2
    v_mul_f32 v52, 0xbfb8aa3b, v52
    v_mul_f32 v53, 0xbfb8aa3b, v53
    v_mul_f32 v54, 0xbfb8aa3b, v54
    v_mul_f32 v55, 0xbfb8aa3b, v55
    v_mul_f32 v56, 0xbfb8aa3b, v56
    v_mul_f32 v57, 0xbfb8aa3b, v57
    v_mul_f32 v58, 0xbfb8aa3b, v58
    v_mul_f32 v59, 0xbfb8aa3b, v59
    v_mul_f32 v60, 0xbfb8aa3b, v60
    v_mul_f32 v61, 0xbfb8aa3b, v61
    v_mul_f32 v62, 0xbfb8aa3b, v62
    v_mul_f32 v63, 0xbfb8aa3b, v63
    v_mul_f32 v64, 0xbfb8aa3b, v64
    v_mul_f32 v65, 0xbfb8aa3b, v65
    v_mul_f32 v66, 0xbfb8aa3b, v66
    v_mul_f32 v67, 0xbfb8aa3b, v67
    v_cvt_pk_bf16_f32 v68, v52, v53
    v_cvt_pk_bf16_f32 v69, v54, v55
    v_cvt_pk_bf16_f32 v70, v56, v57
    v_cvt_pk_bf16_f32 v71, v58, v59
    v_cvt_pk_bf16_f32 v72, v60, v61
    v_cvt_pk_bf16_f32 v73, v62, v63
    v_cvt_pk_bf16_f32 v74, v64, v65
    v_cvt_pk_bf16_f32 v75, v66, v67
    s_mov_b32 exec_lo, 0xfffff
    s_mov_b32 exec_hi, 0xfffff
    ds_write_b128 v140, v[68:71] offset:0
    ds_write_b128 v140, v[72:75] offset:16
    s_mov_b64 exec, -1
    ds_read_b128 v[76:79], v141 offset:0
    ds_read_b128 v[80:83], v141 offset:1280
    s_add_u32 s78, s89, 0x9e3779ba
    s_mul_i32 s78, s78, 0x85ebca6b
    s_lshr_b32 s3, s78, 15
    s_xor_b32 s78, s78, s3
    s_mul_i32 s78, s78, 0xc2b2ae35
    s_and_b32 s78, s78, -16
    s_or_b32 s78, s78, 4
    s_add_u32 s79, s89, 0x9e3779bb
    s_mul_i32 s79, s79, 0x85ebca6b
    s_lshr_b32 s3, s79, 15
    s_xor_b32 s79, s79, s3
    s_mul_i32 s79, s79, 0xc2b2ae35
    s_and_b32 s79, s79, -16
    s_or_b32 s79, s79, 8
    s_waitcnt lgkmcnt(0)
    buffer_store_dwordx4 v[76:79], v[142:143], s[28:31], 0 idxen offen sc1
    v_add_u32 v142, 16, v142
    s_mov_b64 exec, 0xffff
    buffer_store_dwordx4 v[80:83], v[142:143], s[28:31], 0 idxen offen sc1
    s_mov_b64 exec, -1
    s_waitcnt vmcnt(4)
    s_branch L_y2
L_st_y1:
    s_branch L_back1
L_y1:
    ds_read_b128 v[4:7], v127 offset:0
    ds_read_b128 v[8:11], v127 offset:32
    ds_read_b128 v[12:15], v127 offset:64
    ds_read_b128 v[16:19], v127 offset:96
    s_add_u32 s76, s89, 0x9e3779b8
    s_mul_i32 s76, s76, 0x85ebca6b
    s_lshr_b32 s3, s76, 15
    s_xor_b32 s76, s76, s3
    s_mul_i32 s76, s76, 0xc2b2ae35
    s_and_b32 s76, s76, -16
    s_or_b32 s76, s76, 1
    s_add_u32 s77, s89, 0x9e3779b9
    s_mul_i32 s77, s77, 0x85ebca6b
    s_lshr_b32 s3, s77, 15
    s_xor_b32 s77, s77, s3
    s_mul_i32 s77, s77, 0xc2b2ae35
    s_and_b32 s77, s77, -16
    s_or_b32 s77, s77, 2
    s_add_u32 s78, s89, 0x9e3779ba
    s_mul_i32 s78, s78, 0x85ebca6b
    s_lshr_b32 s3, s78, 15
    s_xor_b32 s78, s78, s3
    s_mul_i32 s78, s78, 0xc2b2ae35
    s_and_b32 s78, s78, -16
    s_or_b32 s78, s78, 4
    s_add_u32 s79, s89, 0x9e3779bb
    s_mul_i32 s79, s79, 0x85ebca6b
    s_lshr_b32 s3, s79, 15
    s_xor_b32 s79, s79, s3
    s_mul_i32 s79, s79, 0xc2b2ae35
    s_and_b32 s79, s79, -16
    s_or_b32 s79, s79, 8
    s_add_u32 m0, s93, 41472
    s_nop 0
    buffer_load_dwordx4 v124, s[40:43], 0 offen lds
    s_add_u32 m0, s93, 60032
    s_nop 0
    buffer_load_dwordx4 v124, s[44:47], 0 offen lds
    s_add_u32 m0, s93, 68224
    s_nop 0
    buffer_load_dwordx4 v124, s[44:47], s67 offen lds
    s_branch L_sk_y2
L_st_y2:
    s_branch L_back1
L_sk_y2:
    s_waitcnt vmcnt(5)
L_y2:
    v_mul_u32_u24 v100, 429497, v84
    v_lshrrev_b32 v105, 22, v100
    v_and_b32 v105, -4, v105
    ds_add_rtn_u32 v110, v105, v160 offset:37376
    v_mul_u32_u24 v101, 429497, v85
    v_lshrrev_b32 v106, 22, v101
    v_and_b32 v106, -4, v106
    ds_add_rtn_u32 v111, v106, v160 offset:37376
    v_mul_u32_u24 v102, 429497, v86
    v_lshrrev_b32 v107, 22, v102
    v_and_b32 v107, -4, v107
    ds_add_rtn_u32 v112, v107, v160 offset:37376
    v_mul_u32_u24 v103, 429497, v87
    v_lshrrev_b32 v108, 22, v103
    v_and_b32 v108, -4, v108
    ds_add_rtn_u32 v113, v108, v160 offset:37376
    s_mov_b64 exec, s[58:59]
    v_mul_u32_u24 v104, 429497, v88
    v_lshrrev_b32 v109, 22, v104
    v_and_b32 v109, -4, v109
    ds_add_rtn_u32 v114, v109, v160 offset:37376
    s_mov_b64 exec, -1
    v_lshrrev_b32 v100, 21, v100
    v_mul_u32_u24 v100, 399, v100
    v_lshrrev_b32 v100, 7, v100
    v_add3_u32 v100, v100, v84, 1
    v_and_or_b32 v100, v100, 63, v148
    v_lshrrev_b32 v101, 21, v101
    v_mul_u32_u24 v101, 399, v101
    v_lshrrev_b32 v101, 7, v101
    v_add3_u32 v101, v101, v85, 1
    v_and_or_b32 v101, v101, 63, v149
    v_lshrrev_b32 v102, 21, v102
    v_mul_u32_u24 v102, 399, v102
    v_lshrrev_b32 v102, 7, v102
    v_add3_u32 v102, v102, v86, 1
    v_and_or_b32 v102, v102, 63, v150
    v_lshrrev_b32 v103, 21, v103
    v_mul_u32_u24 v103, 399, v103
    v_lshrrev_b32 v103, 7, v103
    v_add3_u32 v103, v103, v87, 1
    v_and_or_b32 v103, v103, 63, v151
    v_lshrrev_b32 v104, 21, v104
    v_mul_u32_u24 v104, 399, v104
    v_lshrrev_b32 v104, 7, v104
    v_add3_u32 v104, v104, v88, 1
    v_and_or_b32 v104, v104, 63, v152
    s_xor_b32 s90, s76, s77
    s_xor_b32 s90, s90, s78
    s_xor_b32 s90, s90, s79
    s_bitcmp1_b32 s2, 6
    s_cselect_b32 s89, s77, s76
    s_cselect_b32 s3, s79, s78
    s_bitcmp1_b32 s2, 7
    s_cselect_b32 s89, s3, s89
    s_cmp_ge_u32 s26, 4
    s_waitcnt vmcnt(3) lgkmcnt(0)
    s_cbranch_scc1 L_srcok
    s_waitcnt vmcnt(2)
L_srcok:
    v_min_u32 v110, 120, v110
    v_lshl_or_b32 v100, v92, 18, v100
    v_mad_u32_u24 v110, v105, 36, v110
    ds_write_b32 v110, v100 offset:516
    v_min_u32 v111, 120, v111
    v_lshl_or_b32 v101, v93, 18, v101
    v_mad_u32_u24 v111, v106, 36, v111
    ds_write_b32 v111, v101 offset:516
    v_min_u32 v112, 120, v112
    v_lshl_or_b32 v102, v94, 18, v102
    v_mad_u32_u24 v112, v107, 36, v112
    ds_write_b32 v112, v102 offset:516
    v_min_u32 v113, 120, v113
    v_lshl_or_b32 v103, v95, 18, v103
    v_mad_u32_u24 v113, v108, 36, v113
    ds_write_b32 v113, v103 offset:516
    s_mov_b64 exec, s[58:59]
    v_min_u32 v114, 120, v114
    v_lshl_or_b32 v104, v96, 18, v104
    v_mad_u32_u24 v114, v109, 36, v114
    ds_write_b32 v114, v104 offset:516
    s_mov_b64 exec, -1
    s_cmp_gt_u32 s26, 3
    s_cbranch_scc1 L_odone
    s_branch L_o0
L_o3:
    v_lshlrev_b32 v231, 1, v1
    global_load_ushort v184, v231, s[16:17]
    s_branch L_odone
L_o1:
    s_mov_b32 s66, 15488
    buffer_load_dwordx4 v[184:187], v124, s[40:43], s66 offen
    s_branch L_odone
L_o0:
    s_cmp_eq_u32 s26, 3
    s_cbranch_scc1 L_o3
    s_cmp_lg_u32 s26, 0
    s_cbranch_scc1 L_o1
    v_lshlrev_b32 v231, 2, v1
    s_mov_b32 m0, 59904
    s_mov_b32 s66, 16384
    s_mov_b32 exec_hi, 0
    buffer_load_dword v231, s[40:43], s66 offen lds
    s_mov_b64 exec, -1
L_odone:
    s_cmp_ge_u32 s26, 4
    s_cbranch_scc1 L_old1
    s_add_u32 m0, s93, 41472
    s_nop 0
    buffer_load_dwordx4 v124, s[40:43], 0 offen lds
    s_add_u32 m0, s93, 60032
    s_nop 0
    buffer_load_dwordx4 v124, s[44:47], 0 offen lds
    s_add_u32 m0, s93, 68224
    s_nop 0
    buffer_load_dwordx4 v124, s[44:47], s67 offen lds
L_old1:
    s_branch L_sk_p2
.p2align 12
L_st_p2:
    s_branch L_back1
L_lt_p2:
    s_branch L_back3
L_sk_p2:
    s_mov_b32 s44, s6
    s_mov_b32 s45, s7
    s_mov_b32 s46, 60000
    s_mov_b32 s47, 0x20000
    s_add_u32 m0, s93, 125568
    s_mov_b32 s64, 49152
    buffer_load_dwordx4 v125, s[44:47], s64 offen lds
    s_add_u32 m0, s93, 117376
    s_mov_b32 s64, 40960
    buffer_load_dwordx4 v125, s[44:47], s64 offen lds
    s_mov_b32 s48, 0x11111111
    s_mov_b32 s49, 0x11111111
    s_mov_b32 s50, 0x88888888
    s_mov_b32 s51, 0x88888888
    s_and_b32 s3, s89, 15
    s_lshl_b32 s3, s3, 4
    s_xor_b32 s3, s3, s89
    v_mov_b32 v231, s89
    v_mov_b32 v232, s3
    s_cmp_ge_u32 s26, 4
    s_cbranch_scc1 L_old2
    s_waitcnt vmcnt(6)
L_old2:
    s_waitcnt lgkmcnt(0)
    s_barrier
    ds_read_b128 v[84:87], v118 offset:512
    ds_read_b128 v[88:91], v118 offset:18944
    ds_read_b128 v[92:95], v118 offset:576
    ds_read_b32 v100, v119 offset:37376
    ds_read_b128 v[96:99], v118 offset:19008
    ds_read_b32 v101, v119 offset:37888
    s_mov_b32 s66, 4243456
    s_waitcnt lgkmcnt(4)
    v_bitop3_b32 v104, v84, v85, v86 bitop3:0x96
    v_xor_b32 v104, v104, v87
    v_bitop3_b32 v105, v88, v89, v90 bitop3:0x96
    v_xor_b32 v105, v105, v91
    s_nop 0
    v_xor_b32_dpp v104, v104, v104 quad_perm:[1,0,3,2] row_mask:0xf bank_mask:0xf
    v_xor_b32_dpp v105, v105, v105 quad_perm:[1,0,3,2] row_mask:0xf bank_mask:0xf
    s_nop 0
    v_xor_b32_dpp v104, v104, v104 quad_perm:[2,3,0,1] row_mask:0xf bank_mask:0xf
    v_xor_b32_dpp v105, v105, v105 quad_perm:[2,3,0,1] row_mask:0xf bank_mask:0xf
    s_mov_b64 exec, s[48:49]
    v_xor_b32 v84, v104, v231
    v_xor_b32 v88, v105, v231
    s_mov_b64 exec, -1
    buffer_store_dwordx4 v[84:87], v120, s[36:39], 0 offen sc1
    buffer_store_dwordx4 v[88:91], v121, s[36:39], 0 offen sc1
    s_waitcnt lgkmcnt(0)
    v_cndmask_b32 v95, v95, 0, s[50:51]
    v_cndmask_b32 v99, v99, 0, s[50:51]
    v_bitop3_b32 v106, v92, v93, v94 bitop3:0x96
    v_xor_b32 v106, v106, v95
    v_bitop3_b32 v107, v96, v97, v98 bitop3:0x96
    v_xor_b32 v107, v107, v99
    v_cmp_le_u32 s[52:53], 60, v100
    v_cmp_lt_u32 s[56:57], s65, v100
    v_cmp_le_u32 s[54:55], 60, v101
    v_cmp_lt_u32 s[58:59], s65, v101
    v_xor_b32_dpp v106, v106, v106 quad_perm:[1,0,3,2] row_mask:0xf bank_mask:0xf
    v_xor_b32_dpp v107, v107, v107 quad_perm:[1,0,3,2] row_mask:0xf bank_mask:0xf
    v_cndmask_b32 v122, -2.0, v120, s[52:53]
    v_cndmask_b32 v123, -2.0, v121, s[54:55]
    v_xor_b32_dpp v106, v106, v106 quad_perm:[2,3,0,1] row_mask:0xf bank_mask:0xf
    v_xor_b32_dpp v107, v107, v107 quad_perm:[2,3,0,1] row_mask:0xf bank_mask:0xf
    v_cndmask_b32 v108, v231, v232, s[56:57]
    v_cndmask_b32 v109, v231, v232, s[58:59]
    s_mov_b64 exec, s[50:51]
    v_xor_b32 v95, v106, v108
    v_xor_b32 v99, v107, v109
    s_or_b64 exec, s[52:53], 1
    buffer_store_dwordx4 v[92:95], v122, s[36:39], s66 offen sc1
    s_or_b64 exec, s[54:55], 1
    buffer_store_dwordx4 v[96:99], v123, s[36:39], s66 offen sc1
    s_mov_b64 exec, -1
    s_waitcnt vmcnt(6)
    s_branch L_sk_b3
L_st_b3:
    s_branch L_back1
L_sk_b3:
    s_setprio 0
    s_barrier
    ds_read_b64_tr_b16 v[84:85], v128 offset:0
    ds_read_b64_tr_b16 v[86:87], v128 offset:512
    ds_read_b64_tr_b16 v[88:89], v128 offset:2048
    ds_read_b64_tr_b16 v[90:91], v128 offset:2560
    ds_read_b64_tr_b16 v[92:93], v128 offset:4096
    ds_read_b64_tr_b16 v[94:95], v128 offset:4608
    ds_read_b64_tr_b16 v[96:97], v128 offset:6144
    ds_read_b64_tr_b16 v[98:99], v128 offset:6656
    v_and_b32 v231, 48, v1
    v_and_b32 v232, 0x70, v125
    v_xor_b32 v189, v231, v232
    v_xor_b32 v191, 64, v189
    v_mov_b32 v193, v189
    v_mov_b32 v195, v191
    v_and_b32 v197, 16, v189
    v_mov_b32 v188, -1
    v_mov_b32 v190, -1
    v_mov_b32 v192, -1
    v_mov_b32 v194, -1
    v_mov_b32 v196, -1
    s_waitcnt lgkmcnt(6)
    v_mfma_f32_32x32x16_bf16 v[100:115], v[84:87], v[4:7], 0
    s_waitcnt lgkmcnt(4)
    v_mfma_f32_32x32x16_bf16 v[100:115], v[88:91], v[8:11], v[100:115]
    s_waitcnt lgkmcnt(2)
    v_mfma_f32_32x32x16_bf16 v[100:115], v[92:95], v[12:15], v[100:115]
    s_waitcnt lgkmcnt(0)
    v_mfma_f32_32x32x16_bf16 v[100:115], v[96:99], v[16:19], v[100:115]
    s_mov_b32 s32, s8
    s_and_b32 s33, s9, 0xffff
    s_or_b32 s33, s33, 0x200000
    s_mov_b32 s34, 640000
    s_mov_b32 s35, 0x20000
    s_lshr_b32 s64, s2, 4
    s_lshl_b32 s64, s64, 3
    s_and_b32 s3, s2, 7
    s_add_u32 s64, s64, s3
    s_mul_i32 s64, s64, 33152
    s_and_b32 s3, s2, 8
    s_lshl_b32 s3, s3, 3
    s_add_u32 s64, s64, s3
    v_and_b32 v231, 7, v0
    v_and_b32 v230, 0xffffff80, v125
    v_lshl_add_u32 v230, v231, 3, v230
    v_add_u32 v230, s64, v230
    s_movk_i32 s68, 8192
    s_movk_i32 s69, 16384
    s_movk_i32 s70, 24576
    s_mov_b32 exec_lo, 0xfffff
    s_mov_b32 exec_hi, 0xfffff
    ds_write_b128 v129, v[100:103] offset:0
    ds_write_b128 v129, v[104:107] offset:32
    ds_write_b128 v129, v[108:111] offset:64
    ds_write_b128 v129, v[112:115] offset:96
    s_mov_b64 exec, -1
    s_sub_u32 s3, s26, 1
    s_cmp_gt_u32 s3, 2
    s_cbranch_scc1 L_nowx
    s_cmp_eq_u32 s3, 2
    s_cbranch_scc1 L_wx
    v_lshlrev_b32 v231, 16, v184
    v_and_b32 v232, 0xffff0000, v184
    v_mul_f32 v231, 0xbfb8aa3b, v231
    v_mul_f32 v232, 0xbfb8aa3b, v232
    v_cvt_pk_bf16_f32 v184, v231, v232
    v_lshlrev_b32 v231, 16, v185
    v_and_b32 v232, 0xffff0000, v185
    v_mul_f32 v231, 0xbfb8aa3b, v231
    v_mul_f32 v232, 0xbfb8aa3b, v232
    v_cvt_pk_bf16_f32 v185, v231, v232
    v_lshlrev_b32 v231, 16, v186
    v_and_b32 v232, 0xffff0000, v186
    v_mul_f32 v231, 0xbfb8aa3b, v231
    v_mul_f32 v232, 0xbfb8aa3b, v232
    v_cvt_pk_bf16_f32 v186, v231, v232
    v_lshlrev_b32 v231, 16, v187
    v_and_b32 v232, 0xffff0000, v187
    v_mul_f32 v231, 0xbfb8aa3b, v231
    v_mul_f32 v232, 0xbfb8aa3b, v232
    v_cvt_pk_bf16_f32 v187, v231, v232
    ds_write_b128 v126, v[184:187] offset:7168
    s_branch L_nowx
L_wx:
    v_lshlrev_b32 v184, 16, v184
    v_lshlrev_b32 v231, 2, v1
    ds_write_b32 v231, v184 offset:256
L_nowx:
    v_mfma_f32_16x16x4_4b_bf16 v[52:67], v[208:209], v[208:209], 0
    v_mfma_f32_16x16x4_4b_bf16 v[68:83], v[208:209], v[208:209], 0
    v_mfma_f32_16x16x4_4b_bf16 v[20:35], v[208:209], v[208:209], 0
    v_mfma_f32_16x16x4_4b_bf16 v[36:51], v[208:209], v[208:209], 0
    ds_read_u16_d16_hi v218, v132 offset:0
    ds_read_u16_d16_hi v219, v132 offset:64
    ds_read_u16_d16_hi v220, v133 offset:0
    ds_read_u16_d16_hi v221, v133 offset:64
    ds_read_u16_d16_hi v222, v134 offset:0
    ds_read_u16_d16_hi v223, v134 offset:64
    s_cmp_gt_u32 s26, 2
    s_cbranch_scc1 L_ptail
    v_add_u32 v235, 57344, v125
    s_add_u32 m0, s93, 133760
    v_cmpx_gt_u32 vcc, 60032, v235
    buffer_load_dwordx4 v235, s[44:47], 0 offen lds
    s_mov_b64 exec, -1
L_ptail:
    s_add_u32 m0, s93, 76416
    s_mov_b32 s64, 0
    buffer_load_dwordx4 v125, s[44:47], s64 offen lds
    s_add_u32 m0, s93, 84608
    s_mov_b32 s64, 8192
    buffer_load_dwordx4 v125, s[44:47], s64 offen lds
    s_add_u32 m0, s93, 92800
    s_mov_b32 s64, 16384
    buffer_load_dwordx4 v125, s[44:47], s64 offen lds
    s_add_u32 m0, s93, 100992
    s_mov_b32 s64, 24576
    buffer_load_dwordx4 v125, s[44:47], s64 offen lds
    s_add_u32 m0, s93, 109184
    s_mov_b32 s64, 32768
    buffer_load_dwordx4 v125, s[44:47], s64 offen lds
    s_waitcnt lgkmcnt(0)
    s_barrier
    buffer_load_dwordx2 v[172:173], v230, s[36:39], 0 offen sc1
    buffer_load_dwordx2 v[174:175], v230, s[36:39], s68 offen sc1
    buffer_load_dwordx2 v[176:177], v230, s[36:39], s69 offen sc1
    buffer_load_dwordx2 v[178:179], v230, s[36:39], s70 offen sc1
    ds_read_b32 v148, v130 offset:0
    ds_read_b32 v149, v130 offset:272
    ds_read_b32 v150, v130 offset:544
    ds_read_b32 v151, v130 offset:816
    ds_read_b32 v152, v130 offset:1088
    ds_read_u16 v153, v135 offset:0
    ds_read_b32 v156, v130 offset:128
    ds_read_b32 v157, v130 offset:400
    ds_read_b32 v158, v130 offset:672
    ds_read_b32 v159, v130 offset:944
    ds_read_b32 v160, v130 offset:1216
    ds_read_u16 v161, v135 offset:64
    s_branch L_sk_poll
L_st_poll:
    s_branch L_back1
L_sk_poll:
    s_mul_i32 s80, s26, 5120
    s_add_u32 s80, s80, 512
    s_add_u32 s22, s80, 4096
    s_mul_i32 s87, s27, 6
    s_add_u32 s87, s87, 76410
    s_mov_b32 s91, 0
    s_mov_b32 s86, 0
    s_mov_b32 s92, 0
    s_mov_b32 s95, 0
    v_and_b32 v231, 56, v1
    v_add3_u32 v244, v231, s81, 4
    v_lshrrev_b32 v231, 1, v1
    v_lshl_add_u32 v245, v231, 3, s81
    v_mov_b32 v203, v244
    v_mov_b32 v204, v245
    v_mov_b32 v252, 8
    v_add_u32 v249, 10240000, v248
    v_add_u32 v250, 20480000, v248
    v_add_u32 v251, 30720000, v248
    s_waitcnt lgkmcnt(5)
    ds_read_b64_tr_b16 v[36:37], v3 offset:16384
    ds_read_b64_tr_b16 v[38:39], v3 offset:16896
    ds_read_b64_tr_b16 v[40:41], v136 offset:16384
    ds_read_b64_tr_b16 v[42:43], v136 offset:16896
    ds_read_b32 v237, v131 offset:10880
    ds_read_b32 v238, v131 offset:11008
    ds_read_b32 v239, v131 offset:11424
    ds_read_b32 v240, v131 offset:11552
    ds_read_b32 v241, v131 offset:11968
    ds_read_b32 v242, v131 offset:12096
    s_mov_b32 exec_lo, 0x80808080
    s_mov_b32 exec_hi, 0x80808080
    v_mov_b32 v165, s76
    v_mov_b32 v167, s77
    v_mov_b32 v169, s78
    v_mov_b32 v171, s79
    s_mov_b64 exec, -1
    s_and_b32 s64, s2, 0xc0
    s_bfe_u32 s3, s2, 0x30003
    s_add_u32 s64, s64, s3
    s_lshl_b32 s3, s26, 3
    s_add_u32 s64, s64, s3
    s_mul_i32 s64, s64, 5000
    s_add_u32 s64, s64, 127
    s_lshr_b32 s64, s64, 7
    v_add_u32 v19, s64, v1
    v_and_b32 v234, 31, v1
    v_bfe_u32 v231, v1, 1, 3
    v_xor_b32 v231, v231, v2
    v_lshlrev_b32 v231, 4, v231
    v_lshl_add_u32 v231, v234, 7, v231
    v_add_u32 v198, s80, v231
    v_xor_b32 v199, 32, v198
    v_xor_b32 v200, 64, v198
    v_xor_b32 v201, 0x60, v198
    v_bfe_u32 v231, v1, 3, 1
    v_xor_b32 v231, v231, v2
    v_lshlrev_b32 v231, 4, v231
    v_lshl_add_u32 v231, v234, 5, v231
    v_add_u32 v202, s22, v231
    v_lshl_add_u32 v246, v234, 3, s81
    v_mov_b32 v226, 0x3f003f00
    v_mov_b32 v227, 0x3f003f00
    v_and_b32 v231, 15, v1
    v_lshlrev_b32 v138, 3, v231
    v_mul_u32_u24 v139, 3328, v231
    v_add_u32 v139, 139776, v139
    s_mov_b64 s[66:67], 0xff
    v_cndmask_b32_e64 v139, 0, v139, s[66:67]
    s_cmp_eq_u32 s26, 0
    s_cbranch_scc1 L_lt_p3
    s_cmp_eq_u32 s26, 1
    s_cbranch_scc1 L_lt_last
L_back2:
    s_waitcnt vmcnt(0) lgkmcnt(0)
L_poll:
    v_bitop3_b32 v84, v172, v173, v174 bitop3:0x96
    v_bitop3_b32 v85, v175, v176, v177 bitop3:0x96
    v_bitop3_b32 v84, v84, v178, v179 bitop3:0x96
    v_xor_b32 v84, v84, v85
    v_cmp_ne_u32 s[48:49], 0, v172
    v_and_b32 v140, 0x38, v172
    v_xor_b32_dpp v84, v84, v84 quad_perm:[1,0,3,2] row_mask:0xf bank_mask:0xf
    v_cmp_ne_u32 s[50:51], 0, v173
    v_and_b32 v141, 0x38, v173
    v_xor_b32_dpp v84, v84, v84 quad_perm:[2,3,0,1] row_mask:0xf bank_mask:0xf
    v_cmp_ne_u32 s[52:53], 0, v174
    v_and_b32 v142, 0x38, v174
    v_xor_b32_dpp v84, v84, v84 row_half_mirror row_mask:0xf bank_mask:0xf
    v_cmp_ne_u32 vcc, s90, v84
    s_add_u32 s91, s91, 1
    s_cbranch_vccz L_got
    s_mov_b64 exec, vcc
    buffer_load_dwordx2 v[172:173], v230, s[36:39], 0 offen sc1
    buffer_load_dwordx2 v[174:175], v230, s[36:39], s68 offen sc1
    buffer_load_dwordx2 v[176:177], v230, s[36:39], s69 offen sc1
    buffer_load_dwordx2 v[178:179], v230, s[36:39], s70 offen sc1
    s_mov_b64 exec, -1
    s_cmp_le_u32 s91, 20000
    s_waitcnt vmcnt(0)
    s_cbranch_scc1 L_poll
    s_mov_b32 s95, 1
L_got:
    s_and_b32 s48, s48, 0xfefefefe
    s_and_b32 s49, s49, 0xfefefefe
    s_mov_b64 exec, s[48:49]
    ds_add_rtn_u32 v140, v140, v252
    s_mov_b64 exec, s[50:51]
    ds_add_rtn_u32 v141, v141, v252
    s_mov_b64 exec, -1
    v_and_b32 v92, 0x3ffff, v172
    v_lshrrev_b32 v93, 18, v172
    v_add_u32 v92, v92, v248
    v_and_b32 v94, 0x3ffff, v173
    v_lshrrev_b32 v95, 18, v173
    v_add_u32 v94, v94, v248
    v_cmp_ne_u32 s[54:55], 0, v175
    v_and_b32 v143, 0x38, v175
    v_cmp_ne_u32 s[56:57], 0, v176
    v_and_b32 v144, 0x38, v176
    v_cmp_ne_u32 s[58:59], 0, v177
    v_and_b32 v145, 0x38, v177
    v_cmp_ne_u32 s[60:61], 0, v178
    v_and_b32 v146, 0x38, v178
    v_cmp_ne_u32 s[62:63], 0, v179
    v_and_b32 v147, 0x38, v179
    s_mov_b32 s66, 0x01010101
    s_mov_b32 s67, 0x01010101
    s_lshr_b64 s[68:69], s[50:51], 7
    s_and_b64 s[68:69], s[68:69], s[66:67]
    s_mulk_i32 s68, 255
    s_mulk_i32 s69, 255
    s_lshr_b64 s[70:71], s[54:55], 7
    s_and_b64 s[70:71], s[70:71], s[66:67]
    s_mulk_i32 s70, 255
    s_mulk_i32 s71, 255
    s_lshr_b64 s[72:73], s[58:59], 7
    s_and_b64 s[72:73], s[72:73], s[66:67]
    s_mulk_i32 s72, 255
    s_mulk_i32 s73, 255
    s_lshr_b64 s[74:75], s[62:63], 7
    s_and_b64 s[74:75], s[74:75], s[66:67]
    s_mulk_i32 s74, 255
    s_mulk_i32 s75, 255
    s_waitcnt lgkmcnt(1)
    s_mov_b64 exec, s[48:49]
    ds_write_b64 v140, v[92:93]
    s_waitcnt lgkmcnt(1)
    s_mov_b64 exec, s[50:51]
    ds_write_b64 v141, v[94:95]
    s_mov_b64 exec, -1
    s_mov_b64 exec, s[68:69]
    s_cbranch_execz L_sl0
    s_mov_b32 s64, 4243456
    buffer_load_dwordx2 v[164:165], v230, s[36:39], s64 offen sc1
L_sl0:
    s_mov_b64 exec, s[70:71]
    s_cbranch_execz L_sl1
    s_mov_b32 s64, 4251648
    buffer_load_dwordx2 v[166:167], v230, s[36:39], s64 offen sc1
L_sl1:
    s_mov_b64 exec, s[72:73]
    s_cbranch_execz L_sl2
    s_mov_b32 s64, 4259840
    buffer_load_dwordx2 v[168:169], v230, s[36:39], s64 offen sc1
L_sl2:
    s_mov_b64 exec, s[74:75]
    s_cbranch_execz L_sl3
    s_mov_b32 s64, 4268032
    buffer_load_dwordx2 v[170:171], v230, s[36:39], s64 offen sc1
L_sl3:
    s_mov_b64 exec, -1
    s_bfm_b64 exec, 16, 0
    buffer_load_dword v247, v19, s[28:31], 0 idxen sc1
    s_mov_b64 exec, -1
    s_branch L_sk_w0
L_st_w0:
    s_branch L_back1
L_sk_w0:
    s_cmp_ge_u32 s26, 4
    s_waitcnt lgkmcnt(0)
    s_barrier
    s_cbranch_scc1 L_noread
    ds_read_b32 v188, v203 offset:0
    ds_read_b32 v190, v203 offset:64
    ds_read_b32 v192, v203 offset:128
    ds_read_b32 v194, v203 offset:192
    ds_read_b32 v196, v204 offset:0
L_noread:
    s_and_b32 s52, s52, 0xfefefefe
    s_and_b32 s53, s53, 0xfefefefe
    s_mov_b64 exec, s[52:53]
    ds_add_rtn_u32 v142, v142, v252
    s_mov_b64 exec, s[54:55]
    ds_add_rtn_u32 v143, v143, v252
    s_mov_b64 exec, -1
    s_cmp_ge_u32 s26, 4
    s_cbranch_scc1 L_noearly
    s_waitcnt lgkmcnt(2)
    v_lshrrev_b32 v196, 6, v196
    v_max3_u32 v88, v188, v190, v192
    v_max_u32 v88, v88, v194
    v_cmp_le_u32 vcc, 640000, v196
    s_mov_b64 s[66:67], vcc
    v_cmp_le_u32 vcc, 10000, v88
    s_or_b64 vcc, vcc, s[66:67]
    s_cbranch_vccnz L_noearly
    s_mov_b32 m0, s22
    s_nop 0
    buffer_load_dwordx4 v[196:197], s[32:35], 0 idxen offen lds
    s_add_u32 m0, s80, 0
    s_nop 0
    buffer_load_dwordx4 v[188:189], s[28:31], 0 idxen offen sc1 lds
    s_add_u32 m0, s80, 1024
    s_nop 0
    buffer_load_dwordx4 v[190:191], s[28:31], 0 idxen offen sc1 lds
    s_add_u32 m0, s80, 2048
    s_nop 0
    buffer_load_dwordx4 v[192:193], s[28:31], 0 idxen offen sc1 lds
    s_add_u32 m0, s80, 3072
    s_nop 0
    buffer_load_dwordx4 v[194:195], s[28:31], 0 idxen offen sc1 lds
    s_mov_b32 s92, 1
L_noearly:
    s_branch L_sk_c
L_st_c:
    s_branch L_back1
L_sk_c:
    s_and_b32 s56, s56, 0xfefefefe
    s_and_b32 s57, s57, 0xfefefefe
    s_mov_b64 exec, s[56:57]
    ds_add_rtn_u32 v144, v144, v252
    s_mov_b64 exec, -1
    s_mov_b32 s66, 0xaaaaaaaa
    s_mov_b32 s67, 0xaaaaaaaa
    v_mov_b32 v231, 0x3f80
    v_cndmask_b32_e64 v231, v231, 1.0, s[66:67]
    s_mov_b32 s78, 3
    s_mov_b32 s79, 0x30000
    s_lshl_b64 s[66:67], s[78:79], 0
    v_cndmask_b32_e64 v4, 0, v231, s[66:67]
    s_lshl_b64 s[66:67], s[78:79], 2
    v_cndmask_b32_e64 v5, 0, v231, s[66:67]
    s_mov_b64 exec, s[58:59]
    ds_add_rtn_u32 v145, v145, v252
    s_mov_b64 exec, -1
    s_lshl_b64 s[66:67], s[78:79], 8
    v_cndmask_b32_e64 v6, 0, v231, s[66:67]
    s_lshl_b64 s[66:67], s[78:79], 10
    v_cndmask_b32_e64 v7, 0, v231, s[66:67]
    s_lshl_b64 s[66:67], s[78:79], 4
    v_cndmask_b32_e64 v8, 0, v231, s[66:67]
    s_lshl_b64 s[66:67], s[78:79], 6
    v_cndmask_b32_e64 v9, 0, v231, s[66:67]
    s_lshl_b64 s[66:67], s[78:79], 12
    v_cndmask_b32_e64 v10, 0, v231, s[66:67]
    s_and_b32 s60, s60, 0xfefefefe
    s_and_b32 s61, s61, 0xfefefefe
    s_mov_b64 exec, s[60:61]
    ds_add_rtn_u32 v146, v146, v252
    s_mov_b64 exec, -1
    s_lshl_b64 s[66:67], s[78:79], 14
    v_cndmask_b32_e64 v11, 0, v231, s[66:67]
    v_lshlrev_b32 v153, 16, v153
    v_mul_f32 v148, 0xbfb8aa3b, v148
    v_mul_f32 v149, 0xbfb8aa3b, v149
    v_mul_f32 v150, 0xbfb8aa3b, v150
    v_mul_f32 v151, 0xbfb8aa3b, v151
    v_mul_f32 v152, 0xbfb8aa3b, v152
    v_mul_f32 v153, 0xbfb8aa3b, v153
    v_and_b32 v154, 0xffff0000, v153
    s_mov_b64 exec, s[62:63]
    ds_add_rtn_u32 v147, v147, v252
    s_mov_b64 exec, -1
    v_sub_f32 v155, v153, v154
    v_lshlrev_b32 v161, 16, v161
    v_mul_f32 v156, 0xbfb8aa3b, v156
    v_mul_f32 v157, 0xbfb8aa3b, v157
    v_mul_f32 v158, 0xbfb8aa3b, v158
    v_mul_f32 v159, 0xbfb8aa3b, v159
    v_mul_f32 v160, 0xbfb8aa3b, v160
    v_mul_f32 v161, 0xbfb8aa3b, v161
    v_and_b32 v162, 0xffff0000, v161
    v_sub_f32 v163, v161, v162
    s_mov_b32 exec_lo, -1
    s_mov_b32 exec_hi, 0
    v_cvt_pk_bf16_f32 v44, v148, v149
    v_cvt_pk_bf16_f32 v45, v150, v151
    v_cvt_pk_bf16_f32 v46, v152, 0
    v_cvt_pk_bf16_f32 v47, v154, v155
    v_cvt_pk_bf16_f32 v48, v156, v157
    v_cvt_pk_bf16_f32 v49, v158, v159
    v_cvt_pk_bf16_f32 v50, v160, 0
    v_cvt_pk_bf16_f32 v51, v162, v163
    s_mov_b32 exec_lo, 0
    s_mov_b32 exec_hi, -1
    v_cvt_pk_bf16_f32 v28, v148, v149
    v_cvt_pk_bf16_f32 v29, v150, v151
    v_cvt_pk_bf16_f32 v30, v152, 0
    v_cvt_pk_bf16_f32 v31, v154, v155
    v_cvt_pk_bf16_f32 v32, v156, v157
    v_cvt_pk_bf16_f32 v33, v158, v159
    v_cvt_pk_bf16_f32 v34, v160, 0
    v_cvt_pk_bf16_f32 v35, v162, v163
    s_mov_b64 exec, -1
    v_and_b32 v92, 0x3ffff, v174
    v_lshrrev_b32 v93, 18, v174
    v_add_u32 v92, v92, v249
    v_and_b32 v94, 0x3ffff, v175
    v_lshrrev_b32 v95, 18, v175
    v_add_u32 v94, v94, v249
    v_and_b32 v96, 0x3ffff, v176
    v_lshrrev_b32 v97, 18, v176
    v_add_u32 v96, v96, v250
    v_and_b32 v98, 0x3ffff, v177
    v_lshrrev_b32 v99, 18, v177
    v_add_u32 v98, v98, v250
    v_and_b32 v100, 0x3ffff, v178
    v_lshrrev_b32 v101, 18, v178
    v_add_u32 v100, v100, v251
    v_and_b32 v102, 0x3ffff, v179
    v_lshrrev_b32 v103, 18, v179
    v_add_u32 v102, v102, v251
    s_cmp_eq_u32 s92, 0
    s_cbranch_scc1 L_w0
    s_waitcnt vmcnt(6)
    s_branch L_w1
.p2align 12
L_st_p3:
    s_branch L_back1
L_lt_p3:
    s_branch L_back2
L_w0:
    s_waitcnt vmcnt(1)
L_w1:
    v_bitop3_b32 v84, v164, v165, v166 bitop3:0x96
    v_bitop3_b32 v85, v167, v168, v169 bitop3:0x96
    v_bitop3_b32 v84, v84, v170, v171 bitop3:0x96
    v_xor_b32 v84, v84, v85
    s_nop 1
    v_xor_b32_dpp v84, v84, v84 quad_perm:[1,0,3,2] row_mask:0xf bank_mask:0xf
    s_nop 1
    v_xor_b32_dpp v84, v84, v84 quad_perm:[2,3,0,1] row_mask:0xf bank_mask:0xf
    s_nop 1
    v_xor_b32_dpp v84, v84, v84 row_half_mirror row_mask:0xf bank_mask:0xf
    v_cmp_ne_u32 vcc, s90, v84
    s_cbranch_vccnz L_sbad
L_sgot:
    s_waitcnt lgkmcnt(5)
    s_mov_b64 exec, s[52:53]
    ds_write_b64 v142, v[92:93]
    s_waitcnt lgkmcnt(5)
    s_mov_b64 exec, s[54:55]
    ds_write_b64 v143, v[94:95]
    s_waitcnt lgkmcnt(5)
    s_mov_b64 exec, s[56:57]
    ds_write_b64 v144, v[96:97]
    s_waitcnt lgkmcnt(5)
    s_mov_b64 exec, s[58:59]
    ds_write_b64 v145, v[98:99]
    s_waitcnt lgkmcnt(5)
    s_mov_b64 exec, s[60:61]
    ds_write_b64 v146, v[100:101]
    s_waitcnt lgkmcnt(5)
    s_mov_b64 exec, s[62:63]
    ds_write_b64 v147, v[102:103]
    s_mov_b64 exec, -1
    v_cmp_ne_u32 s[48:49], 0, v164
    v_cmp_ne_u32 s[50:51], 0, v165
    v_cmp_ne_u32 s[52:53], 0, v166
    v_cmp_ne_u32 s[54:55], 0, v167
    v_cmp_ne_u32 s[56:57], 0, v168
    v_cmp_ne_u32 s[58:59], 0, v169
    v_cmp_ne_u32 s[60:61], 0, v170
    v_cmp_ne_u32 s[62:63], 0, v171
    s_mov_b64 exec, s[48:49]
    s_cbranch_execz L_sa0
    s_and_b32 s50, s50, 0x7f7f7f7f
    s_and_b32 s51, s51, 0x7f7f7f7f
    v_and_b32 v104, 0x38, v164
    v_and_b32 v105, 0x38, v165
    ds_add_rtn_u32 v104, v104, v252
    v_and_b32 v116, 0x3ffff, v164
    v_lshrrev_b32 v117, 18, v164
    v_add_u32 v116, v116, v248
    v_and_b32 v118, 0x3ffff, v165
    v_lshrrev_b32 v119, 18, v165
    v_add_u32 v118, v118, v248
    s_mov_b64 exec, s[50:51]
    ds_add_rtn_u32 v105, v105, v252
L_sa0:
    s_mov_b64 exec, s[52:53]
    s_cbranch_execz L_sa1
    s_and_b32 s54, s54, 0x7f7f7f7f
    s_and_b32 s55, s55, 0x7f7f7f7f
    v_and_b32 v106, 0x38, v166
    v_and_b32 v107, 0x38, v167
    ds_add_rtn_u32 v106, v106, v252
    v_and_b32 v120, 0x3ffff, v166
    v_lshrrev_b32 v121, 18, v166
    v_add_u32 v120, v120, v249
    v_and_b32 v122, 0x3ffff, v167
    v_lshrrev_b32 v123, 18, v167
    v_add_u32 v122, v122, v249
    s_mov_b64 exec, s[54:55]
    ds_add_rtn_u32 v107, v107, v252
L_sa1:
    s_mov_b64 exec, s[56:57]
    s_cbranch_execz L_sa2
    s_and_b32 s58, s58, 0x7f7f7f7f
    s_and_b32 s59, s59, 0x7f7f7f7f
    v_and_b32 v108, 0x38, v168
    v_and_b32 v109, 0x38, v169
    ds_add_rtn_u32 v108, v108, v252
    v_and_b32 v124, 0x3ffff, v168
    v_lshrrev_b32 v125, 18, v168
    v_add_u32 v124, v124, v250
    v_and_b32 v126, 0x3ffff, v169
    v_lshrrev_b32 v127, 18, v169
    v_add_u32 v126, v126, v250
    s_mov_b64 exec, s[58:59]
    ds_add_rtn_u32 v109, v109, v252
L_sa2:
    s_mov_b64 exec, s[60:61]
    s_cbranch_execz L_sa3
    s_and_b32 s62, s62, 0x7f7f7f7f
    s_and_b32 s63, s63, 0x7f7f7f7f
    v_and_b32 v110, 0x38, v170
    v_and_b32 v111, 0x38, v171
    ds_add_rtn_u32 v110, v110, v252
    v_and_b32 v128, 0x3ffff, v170
    v_lshrrev_b32 v129, 18, v170
    v_add_u32 v128, v128, v251
    v_and_b32 v130, 0x3ffff, v171
    v_lshrrev_b32 v131, 18, v171
    v_add_u32 v130, v130, v251
    s_mov_b64 exec, s[62:63]
    ds_add_rtn_u32 v111, v111, v252
L_sa3:
    s_mov_b64 exec, -1
    s_waitcnt lgkmcnt(5)
    s_cmp_lt_u32 s26, 4
    s_cbranch_scc1 L_noread2
    ds_read_b32 v188, v203 offset:0
    ds_read_b32 v190, v203 offset:64
    ds_read_b32 v192, v203 offset:128
    ds_read_b32 v194, v203 offset:192
    ds_read_b32 v196, v204 offset:0
L_noread2:
    ds_write_b64 v137, v[208:209] offset:0
    ds_write_b64 v137, v[208:209] offset:512
    ds_write_b64 v137, v[208:209] offset:1024
    ds_write_b64 v137, v[208:209] offset:1536
    s_branch L_sk_b5
L_st_b5:
    s_branch L_back1
L_sk_b5:
    s_waitcnt lgkmcnt(4)
    s_mov_b64 exec, s[48:49]
    s_cbranch_execz L_sb0
    ds_write_b64 v104, v[116:117]
    s_mov_b64 exec, s[50:51]
    ds_write_b64 v105, v[118:119]
L_sb0:
    s_mov_b64 exec, s[52:53]
    s_cbranch_execz L_sb1
    ds_write_b64 v106, v[120:121]
    s_mov_b64 exec, s[54:55]
    ds_write_b64 v107, v[122:123]
L_sb1:
    s_mov_b64 exec, s[56:57]
    s_cbranch_execz L_sb2
    ds_write_b64 v108, v[124:125]
    s_mov_b64 exec, s[58:59]
    ds_write_b64 v109, v[126:127]
L_sb2:
    s_mov_b64 exec, s[60:61]
    s_cbranch_execz L_sb3
    ds_write_b64 v110, v[128:129]
    s_mov_b64 exec, s[62:63]
    ds_write_b64 v111, v[130:131]
L_sb3:
    s_mov_b64 exec, -1
    s_cmp_eq_u32 s95, 0
    s_cbranch_scc1 L_noflag
    ds_write_b32 v208, v252 offset:64
L_noflag:
    s_cmp_lt_u32 s26, 4
    s_cbranch_scc1 L_yd
    v_lshrrev_b32 v196, 6, v196
    v_max3_u32 v88, v188, v190, v192
    v_max_u32 v88, v88, v194
    v_cmp_le_u32 vcc, 640000, v196
    s_mov_b64 s[66:67], vcc
    v_cmp_le_u32 vcc, 10000, v88
    s_or_b64 vcc, vcc, s[66:67]
    s_cbranch_vccnz L_yd
    s_mov_b32 m0, s22
    s_nop 0
    buffer_load_dwordx4 v[196:197], s[32:35], 0 idxen offen lds
    s_add_u32 m0, s80, 0
    s_nop 0
    buffer_load_dwordx4 v[188:189], s[28:31], 0 idxen offen sc1 lds
    s_add_u32 m0, s80, 1024
    s_nop 0
    buffer_load_dwordx4 v[190:191], s[28:31], 0 idxen offen sc1 lds
    s_add_u32 m0, s80, 2048
    s_nop 0
    buffer_load_dwordx4 v[192:193], s[28:31], 0 idxen offen sc1 lds
    s_add_u32 m0, s80, 3072
    s_nop 0
    buffer_load_dwordx4 v[194:195], s[28:31], 0 idxen offen sc1 lds
    s_mov_b32 s92, 1
L_yd:
    s_setprio 3
    s_waitcnt lgkmcnt(0)
    s_barrier
    ds_read_b32 v231, v138
    s_waitcnt lgkmcnt(0)
    v_cmp_gt_u32 vcc, v231, v139
    v_readlane_b32 s82, v231, s26
    s_and_b32 s85, vcc_lo, 0x1ff
    s_sub_u32 s82, s82, s81
    s_lshr_b32 s82, s82, 3
    s_cmp_eq_u32 s85, 0
    s_cselect_b32 s82, s82, 0
    s_cselect_b32 s92, s92, 0
    s_cselect_b32 s86, 640000, 0
    s_cselect_b32 s64, s2, 0
    s_or_b32 s64, s64, s26
    s_cbranch_scc0 L_epoch
L_round:
    s_add_u32 s83, s82, 31
    s_lshr_b32 s83, s83, 5
    s_cbranch_scc0 L_round_end
    s_lshl_b32 s64, s83, 5
    s_sub_u32 s64, s64, s82
    s_lshr_b32 s23, s64, 3
    s_lshl_b32 s65, s82, 3
    v_add_u32 v231, s65, v246
    s_bfm_b64 exec, s64, 0
    ds_write_b64 v231, v[228:229]
    s_mov_b64 exec, -1
    s_cmp_eq_u32 s92, 0
    s_cbranch_scc1 L_first
L_prime:
    s_mov_b32 s77, 76416
    s_lshl_b32 s76, s83, 8
    s_add_u32 s76, s76, s81
    s_sub_u32 s76, s76, 8
    v_lshl_add_u32 v205, v1, 3, s81
    v_min_u32 v205, s76, v205
    ds_read_b64 v[210:211], v205
    v_add_u32 v205, 512, v205
    v_min_u32 v205, s76, v205
    ds_read_b64 v[224:225], v205
    v_mov_b32 v203, v244
    v_mov_b32 v204, v245
    ds_read_b32 v188, v203 offset:256
    ds_read_b32 v190, v203 offset:320
    ds_read_b32 v192, v203 offset:384
    ds_read_b32 v194, v203 offset:448
    ds_read_b32 v196, v204 offset:256
    v_add_u32 v205, 512, v205
    v_min_u32 v205, s76, v205
    s_mov_b32 s84, 1
    s_mov_b32 s92, 0
    s_waitcnt lgkmcnt(5)
    v_mad_u32_u24 v13, v211, 6, s77
    v_and_b32 v235, 7, v210
    v_mad_u32_u24 v14, v235, 6, s87
    ds_read_u16_d16_hi v212, v13 offset:0
    ds_read_u16_d16_hi v213, v13 offset:2
    ds_read_u16_d16_hi v214, v13 offset:4
    ds_read_u16_d16_hi v215, v14 offset:0
    ds_read_u16_d16_hi v216, v14 offset:2
    ds_read_u16_d16_hi v217, v14 offset:4
    v_mfma_f32_16x16x4_4b_bf16 v[116:131], v[208:209], v[208:209], 0
    v_mfma_f32_16x16x4_4b_bf16 v[132:147], v[208:209], v[208:209], 0
    v_mfma_f32_16x16x4_4b_bf16 v[100:115], v[208:209], v[208:209], 0
    v_lshl_add_u32 v230, v235, 3, v206
    v_lshlrev_b32 v236, 4, v235
    v_mov_b32 v12, v230
    v_mad_u32_u24 v13, v225, 6, s77
    v_and_b32 v235, 7, v224
    v_mad_u32_u24 v14, v235, 6, s87
    s_waitcnt lgkmcnt(0)
    v_sub_f32 v231, v215, v212
    v_sub_f32 v232, v216, v213
    v_sub_f32 v233, v217, v214
    v_cvt_pk_bf16_f32 v210, v231, v232
    v_cvt_pk_bf16_f32 v211, v233, 1.0
    v_lshlrev_b32 v231, 16, v210
    v_and_b32 v232, 0xffff0000, v210
    v_lshlrev_b32 v233, 16, v211
    v_mul_f32 v231, v231, v231
    v_fmac_f32 v231, v232, v232
    v_fmac_f32 v231, v233, v233
    v_cvt_pk_bf16_f32 v171, v231, v231
    s_branch L_tile
L_st_tile:
    s_branch L_back1
.p2align 6
L_tile:
    ds_read_b64_tr_b16 v[172:173], v207 offset:0
    ds_read_b64_tr_b16 v[174:175], v207 offset:512
    ds_read_b64_tr_b16 v[176:177], v207 offset:1024
    ds_read_b64_tr_b16 v[178:179], v207 offset:1536
    ds_write_b64 v12, v[208:209]
    s_mov_b32 exec_hi, 0
    ds_write_b64 v230, v[210:211]
    s_mov_b64 exec, -1
    ds_read_b96 v[168:170], v236 offset:128
    ds_read_u16_d16_hi v212, v13 offset:0
    ds_read_u16_d16_hi v213, v13 offset:2
    ds_read_u16_d16_hi v214, v13 offset:4
    ds_read_u16_d16_hi v215, v14 offset:0
    ds_read_u16_d16_hi v216, v14 offset:2
    ds_read_u16_d16_hi v217, v14 offset:4
    s_waitcnt vmcnt(0) lgkmcnt(9)
    ds_read_b128 v[148:151], v198
    ds_read_b128 v[152:155], v199
    ds_read_b128 v[156:159], v200
    ds_read_b128 v[160:163], v201
    ds_read_b128 v[164:167], v202
    v_lshrrev_b32 v196, 6, v196
    s_mov_b32 m0, s80
    s_cmp_ge_u32 s84, s83
    s_waitcnt lgkmcnt(5)
    v_mfma_f32_32x32x16_bf16 v[84:99], v[168:171], v[44:47], 0
    s_waitcnt lgkmcnt(0)
    s_cbranch_scc1 L_last0
    buffer_load_dwordx4 v[188:189], s[28:31], 0 idxen offen sc1 lds
    s_add_u32 m0, m0, 1024
    v_mfma_f32_32x32x16_bf16 v[84:99], v[164:167], v[36:39], v[84:99]
    buffer_load_dwordx4 v[190:191], s[28:31], 0 idxen offen sc1 lds
    s_add_u32 m0, m0, 1024
    s_add_u32 s84, s84, 1
    buffer_load_dwordx4 v[192:193], s[28:31], 0 idxen offen sc1 lds
    s_add_u32 m0, m0, 1024
    ds_read_b32 v188, v203 offset:512
    buffer_load_dwordx4 v[194:195], s[28:31], 0 idxen offen sc1 lds
    s_add_u32 m0, m0, 1024
    ds_read_b32 v190, v203 offset:576
    buffer_load_dwordx4 v[196:197], s[32:35], 0 idxen offen lds
    ds_read_b32 v192, v203 offset:640
    ds_read_b32 v194, v203 offset:704
    ds_read_b32 v196, v204 offset:512
    s_setprio 0
    v_mul_f32 v132, v100, v132
    v_mul_f32 v133, v101, v133
    v_mul_f32 v134, v102, v134
    v_mul_f32 v135, v103, v135
    v_mul_f32 v136, v104, v136
    v_mul_f32 v137, v105, v137
    v_mul_f32 v138, v106, v138
    v_mul_f32 v139, v107, v139
    v_mul_f32 v140, v108, v140
    v_mul_f32 v141, v109, v141
    v_mul_f32 v142, v110, v142
    v_mul_f32 v143, v111, v143
    v_mul_f32 v144, v112, v144
    v_mul_f32 v145, v113, v145
    v_mul_f32 v146, v114, v146
    v_mul_f32 v147, v115, v147
    s_setprio 1
    v_mfma_f32_32x32x16_bf16 v[84:99], v[148:151], v[4:7], v[84:99]
    v_cvt_pk_bf16_f32 v180, v116, v117
    v_cvt_pk_bf16_f32 v181, v118, v119
    v_cvt_pk_bf16_f32 v182, v120, v121
    v_cvt_pk_bf16_f32 v183, v122, v123
    v_cvt_pk_bf16_f32 v184, v124, v125
    v_cvt_pk_bf16_f32 v185, v126, v127
    v_mfma_f32_32x32x16_bf16 v[84:99], v[152:155], v[8:11], v[84:99]
    v_cvt_pk_bf16_f32 v186, v128, v129
    v_cvt_pk_bf16_f32 v187, v130, v131
    v_cvt_pk_bf16_f32 v20, v132, v133
    v_cvt_pk_bf16_f32 v21, v134, v135
    v_cvt_pk_bf16_f32 v22, v136, v137
    v_cvt_pk_bf16_f32 v23, v138, v139
    v_mfma_f32_32x32x16_bf16 v[100:115], v[168:171], v[48:51], 0
    v_cvt_pk_bf16_f32 v24, v140, v141
    v_cvt_pk_bf16_f32 v25, v142, v143
    v_cvt_pk_bf16_f32 v26, v144, v145
    v_cvt_pk_bf16_f32 v27, v146, v147
    v_sub_f32 v231, v215, v212
    v_mfma_f32_32x32x16_bf16 v[100:115], v[164:167], v[40:43], v[100:115]
    v_exp_f32 v116, v84
    v_exp_f32 v117, v85
    v_exp_f32 v118, v86
    v_mfma_f32_32x32x16_bf16 v[100:115], v[156:159], v[4:7], v[100:115]
    v_exp_f32 v119, v87
    v_exp_f32 v120, v88
    v_exp_f32 v121, v89
    v_mfma_f32_32x32x16_bf16 v[100:115], v[160:163], v[8:11], v[100:115]
    v_exp_f32 v122, v90
    v_exp_f32 v123, v91
    v_exp_f32 v124, v92
    v_exp_f32 v125, v93
    v_mfma_f32_32x32x16_bf16 v[52:67], v[180:183], v[172:175], v[52:67]
    v_exp_f32 v126, v94
    v_exp_f32 v127, v95
    v_exp_f32 v128, v96
    v_exp_f32 v129, v97
    v_exp_f32 v130, v98
    v_exp_f32 v131, v99
    v_sub_f32 v232, v216, v213
    v_sub_f32 v233, v217, v214
    v_mfma_f32_16x16x4_4b_bf16 v[116:131], v[226:227], v[226:227], v[116:131]
    v_exp_f32 v132, v100
    v_exp_f32 v133, v101
    v_exp_f32 v134, v102
    v_exp_f32 v135, v103
    v_mfma_f32_32x32x16_bf16 v[52:67], v[184:187], v[176:179], v[52:67]
    v_exp_f32 v136, v104
    v_exp_f32 v137, v105
    v_exp_f32 v138, v106
    v_exp_f32 v139, v107
    v_mfma_f32_32x32x16_bf16 v[68:83], v[20:23], v[172:175], v[68:83]
    v_exp_f32 v140, v108
    v_exp_f32 v141, v109
    v_exp_f32 v142, v110
    v_exp_f32 v143, v111
    v_exp_f32 v144, v112
    v_exp_f32 v145, v113
    v_exp_f32 v146, v114
    v_exp_f32 v147, v115
    v_rcp_f32 v116, v116
    v_rcp_f32 v117, v117
    v_mfma_f32_16x16x4_4b_bf16 v[132:147], v[226:227], v[226:227], v[132:147]
    v_rcp_f32 v118, v118
    v_rcp_f32 v119, v119
    v_rcp_f32 v120, v120
    v_rcp_f32 v121, v121
    v_mfma_f32_32x32x16_bf16 v[68:83], v[24:27], v[176:179], v[68:83]
    v_rcp_f32 v122, v122
    v_rcp_f32 v123, v123
    s_setprio 2
    v_rcp_f32 v124, v124
    v_rcp_f32 v125, v125
    v_rcp_f32 v126, v126
    v_rcp_f32 v127, v127
    v_rcp_f32 v128, v128
    v_rcp_f32 v129, v129
    v_rcp_f32 v130, v130
    v_rcp_f32 v131, v131
    v_rcp_f32 v132, v132
    v_rcp_f32 v133, v133
    v_rcp_f32 v134, v134
    v_rcp_f32 v135, v135
    v_rcp_f32 v136, v136
    v_rcp_f32 v137, v137
    v_rcp_f32 v138, v138
    v_rcp_f32 v139, v139
    v_rcp_f32 v140, v140
    v_rcp_f32 v141, v141
    v_rcp_f32 v142, v142
    v_rcp_f32 v143, v143
    v_rcp_f32 v144, v144
    v_rcp_f32 v145, v145
    v_rcp_f32 v146, v146
    v_rcp_f32 v147, v147
    v_mul_f32 v116, v84, v116
    v_mul_f32 v117, v85, v117
    v_mul_f32 v118, v86, v118
    v_mul_f32 v119, v87, v119
    v_mul_f32 v120, v88, v120
    v_mul_f32 v121, v89, v121
    v_mul_f32 v122, v90, v122
    v_mul_f32 v123, v91, v123
    v_mul_f32 v124, v92, v124
    v_mul_f32 v125, v93, v125
    v_mul_f32 v126, v94, v126
    v_mul_f32 v127, v95, v127
    v_mul_f32 v128, v96, v128
    v_mul_f32 v129, v97, v129
    v_mul_f32 v130, v98, v130
    v_mul_f32 v131, v99, v131
    s_setprio 3
    ds_read_b64_tr_b16 v[172:173], v207 offset:0
    ds_read_b64_tr_b16 v[174:175], v207 offset:512
    ds_read_b64_tr_b16 v[176:177], v207 offset:1024
    ds_read_b64_tr_b16 v[178:179], v207 offset:1536
    ds_write_b64 v230, v[208:209]
    s_mov_b32 exec_lo, 0
    ds_write_b64 v230, v[210:211]
    s_mov_b64 exec, -1
    ds_read_b64 v[224:225], v205
    s_branch L_sk_odd
L_st_odd:
    s_branch L_back1
L_sk_odd:
    s_waitcnt vmcnt(0) lgkmcnt(7)
    ds_read_b128 v[148:151], v198
    ds_read_b128 v[152:155], v199
    ds_read_b128 v[156:159], v200
    ds_read_b128 v[160:163], v201
    ds_read_b128 v[164:167], v202
    v_lshrrev_b32 v196, 6, v196
    s_mov_b32 m0, s80
    s_cmp_ge_u32 s84, s83
    s_waitcnt lgkmcnt(5)
    v_mfma_f32_32x32x16_bf16 v[84:99], v[168:171], v[28:31], 0
    s_waitcnt lgkmcnt(0)
    s_cbranch_scc1 L_last0
    buffer_load_dwordx4 v[188:189], s[28:31], 0 idxen offen sc1 lds
    s_add_u32 m0, m0, 1024
    v_mfma_f32_32x32x16_bf16 v[84:99], v[164:167], v[36:39], v[84:99]
    buffer_load_dwordx4 v[190:191], s[28:31], 0 idxen offen sc1 lds
    s_add_u32 m0, m0, 1024
    s_add_u32 s84, s84, 1
    buffer_load_dwordx4 v[192:193], s[28:31], 0 idxen offen sc1 lds
    s_add_u32 m0, m0, 1024
    ds_read_b32 v188, v203 offset:768
    buffer_load_dwordx4 v[194:195], s[28:31], 0 idxen offen sc1 lds
    s_add_u32 m0, m0, 1024
    ds_read_b32 v190, v203 offset:832
    buffer_load_dwordx4 v[196:197], s[32:35], 0 idxen offen lds
    ds_read_b32 v192, v203 offset:896
    ds_read_b32 v194, v203 offset:960
    ds_read_b32 v196, v204 offset:768
    s_setprio 0
    v_mul_f32 v132, v100, v132
    v_mul_f32 v133, v101, v133
    v_mul_f32 v134, v102, v134
    v_mul_f32 v135, v103, v135
    v_mul_f32 v136, v104, v136
    v_mul_f32 v137, v105, v137
    v_mul_f32 v138, v106, v138
    v_mul_f32 v139, v107, v139
    v_mul_f32 v140, v108, v140
    v_mul_f32 v141, v109, v141
    v_mul_f32 v142, v110, v142
    v_mul_f32 v143, v111, v143
    v_mul_f32 v144, v112, v144
    v_mul_f32 v145, v113, v145
    v_mul_f32 v146, v114, v146
    v_mul_f32 v147, v115, v147
    s_setprio 1
    v_mfma_f32_32x32x16_bf16 v[84:99], v[148:151], v[4:7], v[84:99]
    v_cvt_pk_bf16_f32 v180, v116, v117
    v_cvt_pk_bf16_f32 v181, v118, v119
    v_cvt_pk_bf16_f32 v182, v120, v121
    v_cvt_pk_bf16_f32 v183, v122, v123
    v_cvt_pk_bf16_f32 v184, v124, v125
    v_cvt_pk_bf16_f32 v185, v126, v127
    v_mfma_f32_32x32x16_bf16 v[84:99], v[152:155], v[8:11], v[84:99]
    v_cvt_pk_bf16_f32 v186, v128, v129
    v_cvt_pk_bf16_f32 v187, v130, v131
    v_cvt_pk_bf16_f32 v20, v132, v133
    v_cvt_pk_bf16_f32 v21, v134, v135
    v_cvt_pk_bf16_f32 v22, v136, v137
    v_cvt_pk_bf16_f32 v23, v138, v139
    v_mfma_f32_32x32x16_bf16 v[100:115], v[168:171], v[32:35], 0
    v_cvt_pk_bf16_f32 v24, v140, v141
    v_cvt_pk_bf16_f32 v25, v142, v143
    v_cvt_pk_bf16_f32 v26, v144, v145
    v_cvt_pk_bf16_f32 v27, v146, v147
    v_cvt_pk_bf16_f32 v210, v231, v232
    v_cvt_pk_bf16_f32 v211, v233, 1.0
    v_lshlrev_b32 v231, 16, v210
    v_and_b32 v232, 0xffff0000, v210
    v_lshlrev_b32 v233, 16, v211
    v_mul_f32 v231, v231, v231
    v_fmac_f32 v231, v232, v232
    v_fmac_f32 v231, v233, v233
    v_mov_b32 v12, v230
    v_lshl_add_u32 v230, v235, 3, v206
    v_lshlrev_b32 v236, 4, v235
    v_mad_u32_u24 v13, v225, 6, s77
    v_and_b32 v235, 7, v224
    v_add_u32 v205, 512, v205
    v_min_u32 v205, s76, v205
    v_mfma_f32_32x32x16_bf16 v[100:115], v[164:167], v[40:43], v[100:115]
    v_exp_f32 v116, v84
    v_exp_f32 v117, v85
    v_exp_f32 v118, v86
    v_mfma_f32_32x32x16_bf16 v[100:115], v[156:159], v[4:7], v[100:115]
    v_exp_f32 v119, v87
    v_exp_f32 v120, v88
    v_exp_f32 v121, v89
    v_mfma_f32_32x32x16_bf16 v[100:115], v[160:163], v[8:11], v[100:115]
    v_exp_f32 v122, v90
    v_exp_f32 v123, v91
    v_exp_f32 v124, v92
    v_exp_f32 v125, v93
    v_mfma_f32_32x32x16_bf16 v[52:67], v[180:183], v[172:175], v[52:67]
    v_exp_f32 v126, v94
    v_exp_f32 v127, v95
    v_exp_f32 v128, v96
    v_exp_f32 v129, v97
    v_exp_f32 v130, v98
    v_exp_f32 v131, v99
    v_cvt_pk_bf16_f32 v171, v231, v231
    v_mad_u32_u24 v14, v235, 6, s87
    v_mfma_f32_16x16x4_4b_bf16 v[116:131], v[226:227], v[226:227], v[116:131]
    v_exp_f32 v132, v100
    v_exp_f32 v133, v101
    v_exp_f32 v134, v102
    v_exp_f32 v135, v103
    v_mfma_f32_32x32x16_bf16 v[52:67], v[184:187], v[176:179], v[52:67]
    v_exp_f32 v136, v104
    v_exp_f32 v137, v105
    v_exp_f32 v138, v106
    v_exp_f32 v139, v107
    v_mfma_f32_32x32x16_bf16 v[68:83], v[20:23], v[172:175], v[68:83]
    v_exp_f32 v140, v108
    v_exp_f32 v141, v109
    v_exp_f32 v142, v110
    v_exp_f32 v143, v111
    v_exp_f32 v144, v112
    v_exp_f32 v145, v113
    v_exp_f32 v146, v114
    v_exp_f32 v147, v115
    v_rcp_f32 v116, v116
    v_rcp_f32 v117, v117
    v_mfma_f32_16x16x4_4b_bf16 v[132:147], v[226:227], v[226:227], v[132:147]
    v_rcp_f32 v118, v118
    v_rcp_f32 v119, v119
    v_rcp_f32 v120, v120
    v_rcp_f32 v121, v121
    v_mfma_f32_32x32x16_bf16 v[68:83], v[24:27], v[176:179], v[68:83]
    v_rcp_f32 v122, v122
    v_rcp_f32 v123, v123
    s_setprio 2
    v_rcp_f32 v124, v124
    v_rcp_f32 v125, v125
    v_rcp_f32 v126, v126
    v_rcp_f32 v127, v127
    v_rcp_f32 v128, v128
    v_rcp_f32 v129, v129
    v_rcp_f32 v130, v130
    v_rcp_f32 v131, v131
    v_rcp_f32 v132, v132
    v_rcp_f32 v133, v133
    v_rcp_f32 v134, v134
    v_rcp_f32 v135, v135
    v_rcp_f32 v136, v136
    v_rcp_f32 v137, v137
    v_rcp_f32 v138, v138
    v_rcp_f32 v139, v139
    v_rcp_f32 v140, v140
    v_rcp_f32 v141, v141
    v_rcp_f32 v142, v142
    v_rcp_f32 v143, v143
    v_rcp_f32 v144, v144
    v_rcp_f32 v145, v145
    v_rcp_f32 v146, v146
    v_rcp_f32 v147, v147
    v_mul_f32 v116, v84, v116
    v_mul_f32 v117, v85, v117
    v_mul_f32 v118, v86, v118
    v_mul_f32 v119, v87, v119
    v_mul_f32 v120, v88, v120
    v_mul_f32 v121, v89, v121
    v_mul_f32 v122, v90, v122
    v_mul_f32 v123, v91, v123
    v_mul_f32 v124, v92, v124
    v_mul_f32 v125, v93, v125
    v_mul_f32 v126, v94, v126
    v_mul_f32 v127, v95, v127
    v_mul_f32 v128, v96, v128
    v_mul_f32 v129, v97, v129
    v_mul_f32 v130, v98, v130
    v_mul_f32 v131, v99, v131
    v_add_u32 v203, 512, v203
    v_add_u32 v204, 512, v204
    s_setprio 3
    s_branch L_tile
.p2align 12
L_st_last:
    s_branch L_back1
L_lt_last:
    s_branch L_back2
L_last0:
    v_mfma_f32_32x32x16_bf16 v[84:99], v[164:167], v[36:39], v[84:99]
L_last:
    s_setprio 0
    v_mul_f32 v132, v100, v132
    v_mul_f32 v133, v101, v133
    v_mul_f32 v134, v102, v134
    v_mul_f32 v135, v103, v135
    v_mul_f32 v136, v104, v136
    v_mul_f32 v137, v105, v137
    v_mul_f32 v138, v106, v138
    v_mul_f32 v139, v107, v139
    v_mul_f32 v140, v108, v140
    v_mul_f32 v141, v109, v141
    v_mul_f32 v142, v110, v142
    v_mul_f32 v143, v111, v143
    v_mul_f32 v144, v112, v144
    v_mul_f32 v145, v113, v145
    v_mul_f32 v146, v114, v146
    v_mul_f32 v147, v115, v147
    s_setprio 1
    s_bitcmp1_b32 s84, 0
    v_mfma_f32_32x32x16_bf16 v[84:99], v[148:151], v[4:7], v[84:99]
    v_cvt_pk_bf16_f32 v180, v116, v117
    v_cvt_pk_bf16_f32 v181, v118, v119
    v_cvt_pk_bf16_f32 v182, v120, v121
    v_cvt_pk_bf16_f32 v183, v122, v123
    v_cvt_pk_bf16_f32 v184, v124, v125
    v_cvt_pk_bf16_f32 v185, v126, v127
    v_mfma_f32_32x32x16_bf16 v[84:99], v[152:155], v[8:11], v[84:99]
    v_cvt_pk_bf16_f32 v186, v128, v129
    v_cvt_pk_bf16_f32 v187, v130, v131
    v_cvt_pk_bf16_f32 v20, v132, v133
    v_cvt_pk_bf16_f32 v21, v134, v135
    v_cvt_pk_bf16_f32 v22, v136, v137
    s_cbranch_scc1 L_le
    v_mfma_f32_32x32x16_bf16 v[100:115], v[168:171], v[32:35], 0
    s_branch L_lo
L_le:
    v_mfma_f32_32x32x16_bf16 v[100:115], v[168:171], v[48:51], 0
L_lo:
    v_cvt_pk_bf16_f32 v23, v138, v139
    v_cvt_pk_bf16_f32 v24, v140, v141
    v_cvt_pk_bf16_f32 v25, v142, v143
    v_cvt_pk_bf16_f32 v26, v144, v145
    v_cvt_pk_bf16_f32 v27, v146, v147
    v_mfma_f32_32x32x16_bf16 v[100:115], v[164:167], v[40:43], v[100:115]
    v_lshrrev_b32 v232, 2, v1
    v_and_b32 v233, 3, v1
    v_add_u32 v232, s27, v232
    v_mul_u32_u24 v232, 6, v232
    v_lshl_add_u32 v232, v233, 1, v232
    v_add_u32 v231, 76416, v232
    v_mfma_f32_32x32x16_bf16 v[100:115], v[156:159], v[4:7], v[100:115]
    ds_read_u16_d16_hi v212, v231
    v_add_u32 v231, s27, v2
    v_lshlrev_b32 v231, 7, v231
    v_and_b32 v233, 31, v1
    v_lshl_add_u32 v231, v233, 1, v231
    v_add_u32 v232, 1280000, v232
    v_mfma_f32_32x32x16_bf16 v[100:115], v[160:163], v[8:11], v[100:115]
    v_xor_b32 v234, 64, v243
    v_lshlrev_b32 v236, 4, v2
    s_cmp_lt_u32 s86, 640000
    s_cbranch_scc1 L_nf1
    ds_read_b64_tr_b16 v[12:13], v243 offset:4096
    ds_read_b64_tr_b16 v[14:15], v243 offset:5120
    v_mfma_f32_32x32x16_bf16 v[52:67], v[180:183], v[172:175], v[52:67]
    ds_read_b64_tr_b16 v[16:17], v243 offset:6144
    ds_read_b64_tr_b16 v[18:19], v243 offset:7168
    ds_read_b64_tr_b16 v[36:37], v234 offset:0
    ds_read_b64_tr_b16 v[38:39], v234 offset:1024
    ds_read_b64_tr_b16 v[40:41], v234 offset:2048
    ds_read_b64_tr_b16 v[42:43], v234 offset:3072
    ds_read_b64_tr_b16 v[44:45], v234 offset:4096
    ds_read_b64_tr_b16 v[46:47], v234 offset:5120
L_nf1b:
    s_cmp_eq_u32 s23, 3
    s_cbranch_scc1 L_x0
    s_cmp_eq_u32 s23, 2
    s_cbranch_scc1 L_x1
    s_cmp_eq_u32 s23, 1
    s_cbranch_scc1 L_x2
L_x3:
    v_exp_f32 v128, v96
    v_exp_f32 v129, v97
    v_exp_f32 v130, v98
    v_exp_f32 v131, v99
    v_exp_f32 v144, v112
    v_exp_f32 v145, v113
    v_exp_f32 v146, v114
    v_exp_f32 v147, v115
L_x2:
    v_exp_f32 v124, v92
    v_exp_f32 v125, v93
    v_exp_f32 v126, v94
    v_exp_f32 v127, v95
    v_exp_f32 v140, v108
    v_exp_f32 v141, v109
    v_exp_f32 v142, v110
    v_exp_f32 v143, v111
L_x1:
    v_exp_f32 v120, v88
    v_exp_f32 v121, v89
    v_exp_f32 v122, v90
    v_exp_f32 v123, v91
    v_exp_f32 v136, v104
    v_exp_f32 v137, v105
    v_exp_f32 v138, v106
    v_exp_f32 v139, v107
L_x0:
    v_mfma_f32_32x32x16_bf16 v[52:67], v[184:187], v[176:179], v[52:67]
    v_exp_f32 v116, v84
    v_exp_f32 v117, v85
    v_exp_f32 v118, v86
    v_exp_f32 v119, v87
    v_mfma_f32_32x32x16_bf16 v[68:83], v[20:23], v[172:175], v[68:83]
    v_exp_f32 v132, v100
    v_exp_f32 v133, v101
    v_exp_f32 v134, v102
    v_exp_f32 v135, v103
    s_cmp_lt_u32 s86, 640000
    v_mfma_f32_32x32x16_bf16 v[68:83], v[24:27], v[176:179], v[68:83]
    s_cbranch_scc1 L_nf2
    s_waitcnt lgkmcnt(3)
    ds_read_b64_tr_b16 v[4:5], v243 offset:0
    ds_read_b64_tr_b16 v[6:7], v243 offset:1024
    ds_read_b64_tr_b16 v[8:9], v243 offset:2048
    ds_read_b64_tr_b16 v[10:11], v243 offset:3072
    ds_read_b64_tr_b16 v[48:49], v234 offset:6144
    v_mfma_f32_16x16x4_4b_bf16 v[116:131], v[226:227], v[226:227], v[116:131]
    ds_read_b64_tr_b16 v[50:51], v234 offset:7168
    ds_read_b128 v[148:151], v236 offset:256
    ds_read_b128 v[152:155], v236 offset:288
    ds_read_b128 v[156:159], v236 offset:320
    ds_read_b128 v[160:163], v236 offset:352
    ds_read_b128 v[164:167], v236 offset:384
    ds_read_b128 v[168:171], v236 offset:416
    v_mfma_f32_16x16x4_4b_bf16 v[132:147], v[226:227], v[226:227], v[132:147]
L_nf2b:
    s_waitcnt lgkmcnt(8)
    ds_read_b64_tr_b16 v[172:173], v207 offset:0
    ds_read_b64_tr_b16 v[174:175], v207 offset:512
    ds_read_b64_tr_b16 v[176:177], v207 offset:1024
    ds_read_b64_tr_b16 v[178:179], v207 offset:1536
    ds_write_b64 v230, v[208:209]
    s_setprio 1
    s_branch L_sk_l2
L_st_l2:
    s_branch L_back1
L_sk_l2:
    s_cmp_eq_u32 s23, 3
    s_cbranch_scc1 L_r0
    s_cmp_eq_u32 s23, 2
    s_cbranch_scc1 L_r1
    s_cmp_eq_u32 s23, 1
    s_cbranch_scc1 L_r2
L_r3:
    v_rcp_f32 v128, v128
    v_rcp_f32 v129, v129
    v_rcp_f32 v130, v130
    v_rcp_f32 v131, v131
    v_rcp_f32 v144, v144
    v_rcp_f32 v145, v145
    v_rcp_f32 v146, v146
    v_rcp_f32 v147, v147
    v_mul_f32 v128, v96, v128
    v_mul_f32 v129, v97, v129
    v_mul_f32 v130, v98, v130
    v_mul_f32 v131, v99, v131
    v_mul_f32 v144, v112, v144
    v_mul_f32 v145, v113, v145
    v_mul_f32 v146, v114, v146
    v_mul_f32 v147, v115, v147
    v_cvt_pk_bf16_f32 v186, v128, v129
    v_cvt_pk_bf16_f32 v187, v130, v131
    v_cvt_pk_bf16_f32 v26, v144, v145
    v_cvt_pk_bf16_f32 v27, v146, v147
L_r2:
    v_rcp_f32 v124, v124
    v_rcp_f32 v125, v125
    v_rcp_f32 v126, v126
    v_rcp_f32 v127, v127
    v_rcp_f32 v140, v140
    v_rcp_f32 v141, v141
    v_rcp_f32 v142, v142
    v_rcp_f32 v143, v143
    v_mul_f32 v124, v92, v124
    v_mul_f32 v125, v93, v125
    v_mul_f32 v126, v94, v126
    v_mul_f32 v127, v95, v127
    v_mul_f32 v140, v108, v140
    v_mul_f32 v141, v109, v141
    v_mul_f32 v142, v110, v142
    v_mul_f32 v143, v111, v143
    v_cvt_pk_bf16_f32 v184, v124, v125
    v_cvt_pk_bf16_f32 v185, v126, v127
    v_cvt_pk_bf16_f32 v24, v140, v141
    v_cvt_pk_bf16_f32 v25, v142, v143
    s_waitcnt lgkmcnt(0)
    s_nop 0
    v_mfma_f32_32x32x16_bf16 v[52:67], v[184:187], v[176:179], v[52:67]
    v_mfma_f32_32x32x16_bf16 v[68:83], v[24:27], v[176:179], v[68:83]
L_r1:
    v_rcp_f32 v120, v120
    v_rcp_f32 v121, v121
    v_rcp_f32 v122, v122
    v_rcp_f32 v123, v123
    v_rcp_f32 v136, v136
    v_rcp_f32 v137, v137
    v_rcp_f32 v138, v138
    v_rcp_f32 v139, v139
    v_mul_f32 v120, v88, v120
    v_mul_f32 v121, v89, v121
    v_mul_f32 v122, v90, v122
    v_mul_f32 v123, v91, v123
    v_mul_f32 v136, v104, v136
    v_mul_f32 v137, v105, v137
    v_mul_f32 v138, v106, v138
    v_mul_f32 v139, v107, v139
    v_cvt_pk_bf16_f32 v182, v120, v121
    v_cvt_pk_bf16_f32 v183, v122, v123
    v_cvt_pk_bf16_f32 v22, v136, v137
    v_cvt_pk_bf16_f32 v23, v138, v139
L_r0:
    v_rcp_f32 v116, v116
    v_rcp_f32 v117, v117
    v_rcp_f32 v118, v118
    v_rcp_f32 v119, v119
    v_rcp_f32 v132, v132
    v_rcp_f32 v133, v133
    v_rcp_f32 v134, v134
    v_rcp_f32 v135, v135
    v_mul_f32 v116, v84, v116
    v_mul_f32 v117, v85, v117
    v_mul_f32 v118, v86, v118
    v_mul_f32 v119, v87, v119
    v_mul_f32 v132, v100, v132
    v_mul_f32 v133, v101, v133
    v_mul_f32 v134, v102, v134
    v_mul_f32 v135, v103, v135
    v_cvt_pk_bf16_f32 v180, v116, v117
    v_cvt_pk_bf16_f32 v181, v118, v119
    v_cvt_pk_bf16_f32 v20, v132, v133
    v_cvt_pk_bf16_f32 v21, v134, v135
    s_cmp_lt_u32 s86, 640000
    s_waitcnt lgkmcnt(0)
    v_mfma_f32_32x32x16_bf16 v[52:67], v[180:183], v[172:175], v[52:67]
    s_cbranch_scc1 L_nf3
    s_mov_b32 s40, s20
    s_mov_b32 s41, s21
    s_mov_b32 s42, 1340000
    s_mov_b32 s43, 0x20000
    s_lshl_b32 s66, s88, 2
    v_mfma_f32_32x32x16_bf16 v[68:83], v[20:23], v[172:175], v[68:83]
    s_setprio 0
    s_bfm_b64 s[66:67], s66, 0
    s_and_b32 s66, s66, 0x77777
    s_branch L_sk_epi
L_st_epi:
    s_branch L_back1
L_sk_epi:
L_epi:
    ds_read_b128 v[172:175], v236 offset:448
    ds_read_b128 v[176:179], v236 offset:480
    v_mul_f32 v52, 0xbf317218, v52
    v_mul_f32 v53, 0xbf317218, v53
    v_mul_f32 v54, 0xbf317218, v54
    v_mul_f32 v55, 0xbf317218, v55
    v_mul_f32 v56, 0xbf317218, v56
    v_mul_f32 v57, 0xbf317218, v57
    v_mul_f32 v58, 0xbf317218, v58
    v_mul_f32 v59, 0xbf317218, v59
    v_cvt_pk_bf16_f32 v84, v52, v53
    v_cvt_pk_bf16_f32 v85, v54, v55
    v_cvt_pk_bf16_f32 v86, v56, v57
    v_cvt_pk_bf16_f32 v87, v58, v59
    v_mul_f32 v60, 0xbf317218, v60
    v_mul_f32 v61, 0xbf317218, v61
    v_mfma_f32_32x32x16_bf16 v[116:131], v[84:87], v[4:7], 0
    v_mul_f32 v62, 0xbf317218, v62
    v_mul_f32 v63, 0xbf317218, v63
    v_mul_f32 v64, 0xbf317218, v64
    v_mul_f32 v65, 0xbf317218, v65
    v_mul_f32 v66, 0xbf317218, v66
    v_mul_f32 v67, 0xbf317218, v67
    v_mfma_f32_32x32x16_bf16 v[132:147], v[84:87], v[36:39], 0
    v_cvt_pk_bf16_f32 v88, v60, v61
    v_cvt_pk_bf16_f32 v89, v62, v63
    v_cvt_pk_bf16_f32 v90, v64, v65
    v_cvt_pk_bf16_f32 v91, v66, v67
    v_mul_f32 v68, 0xbf317218, v68
    v_mul_f32 v69, 0xbf317218, v69
    v_mfma_f32_32x32x16_bf16 v[116:131], v[88:91], v[8:11], v[116:131]
    v_mul_f32 v70, 0xbf317218, v70
    v_mul_f32 v71, 0xbf317218, v71
    v_mul_f32 v72, 0xbf317218, v72
    v_mul_f32 v73, 0xbf317218, v73
    v_mul_f32 v74, 0xbf317218, v74
    v_mul_f32 v75, 0xbf317218, v75
    v_mfma_f32_32x32x16_bf16 v[132:147], v[88:91], v[40:43], v[132:147]
    v_cvt_pk_bf16_f32 v92, v68, v69
    v_cvt_pk_bf16_f32 v93, v70, v71
    v_cvt_pk_bf16_f32 v94, v72, v73
    v_cvt_pk_bf16_f32 v95, v74, v75
    v_mul_f32 v76, 0xbf317218, v76
    v_mul_f32 v77, 0xbf317218, v77
    v_mfma_f32_32x32x16_bf16 v[116:131], v[92:95], v[12:15], v[116:131]
    v_mul_f32 v78, 0xbf317218, v78
    v_mul_f32 v79, 0xbf317218, v79
    v_mul_f32 v80, 0xbf317218, v80
    v_mul_f32 v81, 0xbf317218, v81
    v_mul_f32 v82, 0xbf317218, v82
    v_mul_f32 v83, 0xbf317218, v83
    v_mfma_f32_32x32x16_bf16 v[132:147], v[92:95], v[44:47], v[132:147]
    v_cvt_pk_bf16_f32 v96, v76, v77
    v_cvt_pk_bf16_f32 v97, v78, v79
    v_cvt_pk_bf16_f32 v98, v80, v81
    v_cvt_pk_bf16_f32 v99, v82, v83
    v_mul_f32 v233, v52, v148
    v_fmac_f32 v233, v53, v149
    v_mfma_f32_32x32x16_bf16 v[116:131], v[96:99], v[16:19], v[116:131]
    v_fmac_f32 v233, v54, v150
    v_fmac_f32 v233, v55, v151
    v_fmac_f32 v233, v56, v152
    v_fmac_f32 v233, v57, v153
    v_fmac_f32 v233, v58, v154
    v_fmac_f32 v233, v59, v155
    v_mfma_f32_32x32x16_bf16 v[132:147], v[96:99], v[48:51], v[132:147]
    v_fmac_f32 v233, v60, v156
    v_fmac_f32 v233, v61, v157
    v_fmac_f32 v233, v62, v158
    v_fmac_f32 v233, v63, v159
    v_fmac_f32 v233, v64, v160
    v_fmac_f32 v233, v65, v161
    v_fmac_f32 v233, v66, v162
    v_fmac_f32 v233, v67, v163
    v_fmac_f32 v233, v68, v164
    v_fmac_f32 v233, v69, v165
    v_fmac_f32 v233, v70, v166
    v_fmac_f32 v233, v71, v167
    v_fmac_f32 v233, v72, v168
    v_fmac_f32 v233, v73, v169
    v_fmac_f32 v233, v74, v170
    v_fmac_f32 v233, v75, v171
    s_waitcnt lgkmcnt(0)
    v_fmac_f32 v233, v76, v172
    v_fmac_f32 v233, v77, v173
    v_fmac_f32 v233, v78, v174
    v_fmac_f32 v233, v79, v175
    v_fmac_f32 v233, v80, v176
    v_fmac_f32 v233, v81, v177
    v_fmac_f32 v233, v82, v178
    v_fmac_f32 v233, v83, v179
    v_mov_b32 v234, v233
    v_add_f32 v237, v237, v119
    v_mul_f32 v180, 0xbfb8aa3b, v237
    v_exp_f32 v180, v180
    v_permlane32_swap_b32 v233, v234
    v_add_f32 v239, v239, v123
    v_mul_f32 v182, 0xbfb8aa3b, v239
    v_exp_f32 v182, v182
    v_add_f32 v241, v241, v127
    v_mul_f32 v184, 0xbfb8aa3b, v241
    v_exp_f32 v184, v184
    v_add_f32 v238, v238, v135
    v_mul_f32 v181, 0xbfb8aa3b, v238
    v_exp_f32 v181, v181
    v_add_f32 v240, v240, v139
    v_mul_f32 v183, 0xbfb8aa3b, v240
    v_exp_f32 v183, v183
    v_add_f32 v242, v242, v143
    v_mul_f32 v185, 0xbfb8aa3b, v242
    v_exp_f32 v185, v185
    v_add_f32 v233, v233, v234
    v_add_f32 v233, v233, v212
    v_cvt_pk_bf16_f32 v233, v233, v233
    s_mov_b64 exec, s[66:67]
    buffer_store_short v233, v232, s[40:43], 0 offen sc1
    s_mov_b64 exec, -1
    v_add_f32 v180, 1.0, v180
    v_rcp_f32 v180, v180
    v_add_f32 v181, 1.0, v181
    v_rcp_f32 v181, v181
    v_add_f32 v182, 1.0, v182
    v_rcp_f32 v182, v182
    v_add_f32 v183, 1.0, v183
    v_rcp_f32 v183, v183
    v_add_f32 v184, 1.0, v184
    v_rcp_f32 v184, v184
    v_add_f32 v185, 1.0, v185
    v_rcp_f32 v185, v185
    s_cmp_eq_u32 s88, 5
    v_fmac_f32 v218, v237, v180
    v_fmac_f32 v219, v238, v181
    v_cvt_pk_bf16_f32 v218, v218, v219
    buffer_store_short v218, v231, s[40:43], 0 offen offset:0 sc1
    buffer_store_short_d16_hi v218, v231, s[40:43], 0 offen offset:64 sc1
    v_fmac_f32 v220, v239, v182
    v_fmac_f32 v221, v240, v183
    v_cvt_pk_bf16_f32 v220, v220, v221
    buffer_store_short v220, v231, s[40:43], 0 offen offset:256 sc1
    buffer_store_short_d16_hi v220, v231, s[40:43], 0 offen offset:320 sc1
    s_cbranch_scc0 L_fin
    s_mov_b32 exec_hi, 0
    v_fmac_f32 v222, v241, v184
    v_fmac_f32 v223, v242, v185
    v_cvt_pk_bf16_f32 v222, v222, v223
    buffer_store_short v222, v231, s[40:43], 0 offen offset:512 sc1
    buffer_store_short_d16_hi v222, v231, s[40:43], 0 offen offset:576 sc1
L_fin:
L_done:
    s_endpgm
L_epoch:
    v_mov_b32 v231, 8486912
    s_mov_b64 exec, 1
    global_atomic_add v231, v252, s[24:25]
    s_mov_b64 exec, -1
    s_branch L_round
L_sbad:
    v_xor_b32 v84, s90, v84
    v_and_b32 v84, 0xffffff0f, v84
    v_cmp_ne_u32 vcc, 0, v84
    s_add_u32 s91, s91, 1
    s_cbranch_vccz L_stimeout
    s_cmp_gt_u32 s91, 20000
    s_cbranch_scc1 L_stimeout
    s_mov_b64 exec, s[68:69]
    s_cbranch_execz L_rl0
    s_mov_b32 s64, 4243456
    buffer_load_dwordx2 v[164:165], v230, s[36:39], s64 offen sc1
L_rl0:
    s_mov_b64 exec, s[70:71]
    s_cbranch_execz L_rl1
    s_mov_b32 s64, 4251648
    buffer_load_dwordx2 v[166:167], v230, s[36:39], s64 offen sc1
L_rl1:
    s_mov_b64 exec, s[72:73]
    s_cbranch_execz L_rl2
    s_mov_b32 s64, 4259840
    buffer_load_dwordx2 v[168:169], v230, s[36:39], s64 offen sc1
L_rl2:
    s_mov_b64 exec, s[74:75]
    s_cbranch_execz L_rl3
    s_mov_b32 s64, 4268032
    buffer_load_dwordx2 v[170:171], v230, s[36:39], s64 offen sc1
L_rl3:
    s_mov_b64 exec, -1
    s_waitcnt vmcnt(0)
    s_branch L_w1
L_stimeout:
    s_mov_b32 s95, 1
    s_branch L_sgot
L_first:
    v_mov_b32 v203, v244
    v_mov_b32 v204, v245
    ds_read_b32 v188, v203 offset:0
    ds_read_b32 v190, v203 offset:64
    ds_read_b32 v192, v203 offset:128
    ds_read_b32 v194, v203 offset:192
    ds_read_b32 v196, v204 offset:0
    s_waitcnt lgkmcnt(0)
    v_lshrrev_b32 v196, 6, v196
    s_mov_b32 m0, s22
    s_nop 0
    buffer_load_dwordx4 v[196:197], s[32:35], 0 idxen offen lds
    s_add_u32 m0, s80, 0
    s_nop 0
    buffer_load_dwordx4 v[188:189], s[28:31], 0 idxen offen sc1 lds
    s_add_u32 m0, s80, 1024
    s_nop 0
    buffer_load_dwordx4 v[190:191], s[28:31], 0 idxen offen sc1 lds
    s_add_u32 m0, s80, 2048
    s_nop 0
    buffer_load_dwordx4 v[192:193], s[28:31], 0 idxen offen sc1 lds
    s_add_u32 m0, s80, 3072
    s_nop 0
    buffer_load_dwordx4 v[194:195], s[28:31], 0 idxen offen sc1 lds
    s_branch L_prime
L_nf1:
    v_mfma_f32_32x32x16_bf16 v[52:67], v[180:183], v[172:175], v[52:67]
    s_nop 4
    s_branch L_nf1b
L_nf2:
    v_mfma_f32_16x16x4_4b_bf16 v[116:131], v[226:227], v[226:227], v[116:131]
    v_mfma_f32_16x16x4_4b_bf16 v[132:147], v[226:227], v[226:227], v[132:147]
    s_nop 3
    s_branch L_nf2b
L_nf3:
    v_mfma_f32_32x32x16_bf16 v[68:83], v[20:23], v[172:175], v[68:83]
    s_branch L_more
L_round_end:
    s_cmp_lt_u32 s86, 640000
    s_cbranch_scc1 L_more
    v_lshrrev_b32 v232, 2, v1
    v_and_b32 v233, 3, v1
    v_add_u32 v232, s27, v232
    v_mul_u32_u24 v232, 6, v232
    v_lshl_add_u32 v232, v233, 1, v232
    v_add_u32 v231, 76416, v232
    ds_read_u16_d16_hi v212, v231
    v_add_u32 v231, s27, v2
    v_lshlrev_b32 v231, 7, v231
    v_and_b32 v233, 31, v1
    v_lshl_add_u32 v231, v233, 1, v231
    v_add_u32 v232, 1280000, v232
    v_xor_b32 v234, 64, v243
    v_lshlrev_b32 v236, 4, v2
    ds_read_b64_tr_b16 v[4:5], v243 offset:0
    ds_read_b64_tr_b16 v[6:7], v243 offset:1024
    ds_read_b64_tr_b16 v[8:9], v243 offset:2048
    ds_read_b64_tr_b16 v[10:11], v243 offset:3072
    ds_read_b64_tr_b16 v[12:13], v243 offset:4096
    ds_read_b64_tr_b16 v[14:15], v243 offset:5120
    ds_read_b64_tr_b16 v[16:17], v243 offset:6144
    ds_read_b64_tr_b16 v[18:19], v243 offset:7168
    ds_read_b64_tr_b16 v[36:37], v234 offset:0
    ds_read_b64_tr_b16 v[38:39], v234 offset:1024
    ds_read_b64_tr_b16 v[40:41], v234 offset:2048
    s_waitcnt lgkmcnt(0)
    ds_read_b64_tr_b16 v[42:43], v234 offset:3072
    ds_read_b64_tr_b16 v[44:45], v234 offset:4096
    ds_read_b64_tr_b16 v[46:47], v234 offset:5120
    ds_read_b64_tr_b16 v[48:49], v234 offset:6144
    ds_read_b64_tr_b16 v[50:51], v234 offset:7168
    ds_read_b128 v[148:151], v236 offset:256
    ds_read_b128 v[152:155], v236 offset:288
    ds_read_b128 v[156:159], v236 offset:320
    ds_read_b128 v[160:163], v236 offset:352
    ds_read_b128 v[164:167], v236 offset:384
    ds_read_b128 v[168:171], v236 offset:416
    s_mov_b32 s40, s20
    s_mov_b32 s41, s21
    s_mov_b32 s42, 1340000
    s_mov_b32 s43, 0x20000
    s_lshl_b32 s66, s88, 2
    s_bfm_b64 s[66:67], s66, 0
    s_and_b32 s66, s66, 0x77777
    s_waitcnt lgkmcnt(0)
    s_branch L_epi
L_more:
    s_cmp_lg_u32 s86, 0
    s_cbranch_scc1 L_havetab
    s_mov_b32 s44, s4
    s_and_b32 s45, s5, 0xffff
    s_or_b32 s45, s45, 0x800000
    s_mov_b32 s46, 10000
    s_mov_b32 s47, 0x20000
    v_lshlrev_b32 v231, 4, v0
    v_and_b32 v232, 16, v1
    v_lshlrev_b32 v232, 2, v232
    v_xor_b32 v231, v231, v232
    s_add_u32 m0, s93, 512
    s_movk_i32 s64, 8192
    s_lshl_b32 s65, s26, 11
    s_add_u32 s65, s65, 41472
    v_lshl_add_u32 v233, v1, 3, s65
    s_waitcnt vmcnt(0)
    s_barrier
    ds_write_b64 v233, v[208:209]
    ds_write_b64 v233, v[208:209] offset:512
    ds_write_b64 v233, v[208:209] offset:1024
    ds_write_b64 v233, v[208:209] offset:1536
    buffer_load_dwordx4 v231, s[40:43], s64 offen lds
    v_subrev_u32 v231, 40960, v3
    v_xor_b32 v232, 64, v231
    v_and_b32 v224, 31, v1
    v_lshl_add_u32 v224, s26, 5, v224
    v_lshlrev_b32 v225, 4, v2
    v_lshlrev_b32 v211, 5, v2
    s_mov_b32 s84, s26
    s_waitcnt vmcnt(0)
    s_barrier
    ds_read_b64_tr_b16 v[84:85], v231 offset:0
    ds_read_b64_tr_b16 v[86:87], v231 offset:512
    ds_read_b64_tr_b16 v[88:89], v231 offset:2048
    ds_read_b64_tr_b16 v[90:91], v231 offset:2560
    ds_read_b64_tr_b16 v[92:93], v231 offset:4096
    ds_read_b64_tr_b16 v[94:95], v231 offset:4608
    ds_read_b64_tr_b16 v[96:97], v231 offset:6144
    ds_read_b64_tr_b16 v[98:99], v231 offset:6656
    s_waitcnt lgkmcnt(0)
    ds_read_b64_tr_b16 v[100:101], v232 offset:0
    ds_read_b64_tr_b16 v[102:103], v232 offset:512
    ds_read_b64_tr_b16 v[104:105], v232 offset:2048
    ds_read_b64_tr_b16 v[106:107], v232 offset:2560
    ds_read_b64_tr_b16 v[108:109], v232 offset:4096
    ds_read_b64_tr_b16 v[110:111], v232 offset:4608
    ds_read_b64_tr_b16 v[112:113], v232 offset:6144
    ds_read_b64_tr_b16 v[114:115], v232 offset:6656
    s_waitcnt lgkmcnt(0)
L_tab:
    buffer_load_dwordx4 v[148:151], v[224:225], s[44:47], 0 idxen offen offset:0
    buffer_load_dwordx4 v[152:155], v[224:225], s[44:47], 0 idxen offen offset:32
    buffer_load_dwordx4 v[156:159], v[224:225], s[44:47], 0 idxen offen offset:64
    buffer_load_dwordx4 v[160:163], v[224:225], s[44:47], 0 idxen offen offset:96
    v_mov_b32 v210, v224
    v_add_u32 v224, 256, v224
    s_waitcnt vmcnt(0)
    v_mfma_f32_32x32x16_bf16 v[116:131], v[84:87], v[148:151], 0
    v_mfma_f32_32x32x16_bf16 v[116:131], v[88:91], v[152:155], v[116:131]
    v_mfma_f32_32x32x16_bf16 v[116:131], v[92:95], v[156:159], v[116:131]
    v_mfma_f32_32x32x16_bf16 v[116:131], v[96:99], v[160:163], v[116:131]
    v_mfma_f32_32x32x16_bf16 v[132:147], v[100:103], v[148:151], 0
    v_mfma_f32_32x32x16_bf16 v[132:147], v[104:107], v[152:155], v[132:147]
    v_mfma_f32_32x32x16_bf16 v[132:147], v[108:111], v[156:159], v[132:147]
    v_mfma_f32_32x32x16_bf16 v[132:147], v[112:115], v[160:163], v[132:147]
    s_nop 11
    v_mul_f32 v116, 0xbfb8aa3b, v116
    v_mul_f32 v117, 0xbfb8aa3b, v117
    v_mul_f32 v118, 0xbfb8aa3b, v118
    v_mul_f32 v119, 0xbfb8aa3b, v119
    v_mul_f32 v120, 0xbfb8aa3b, v120
    v_mul_f32 v121, 0xbfb8aa3b, v121
    v_mul_f32 v122, 0xbfb8aa3b, v122
    v_mul_f32 v123, 0xbfb8aa3b, v123
    v_mul_f32 v124, 0xbfb8aa3b, v124
    v_mul_f32 v125, 0xbfb8aa3b, v125
    v_mul_f32 v126, 0xbfb8aa3b, v126
    v_mul_f32 v127, 0xbfb8aa3b, v127
    v_mul_f32 v128, 0xbfb8aa3b, v128
    v_mul_f32 v129, 0xbfb8aa3b, v129
    v_mul_f32 v130, 0xbfb8aa3b, v130
    v_mul_f32 v131, 0xbfb8aa3b, v131
    v_mul_f32 v132, 0xbfb8aa3b, v132
    v_mul_f32 v133, 0xbfb8aa3b, v133
    v_mul_f32 v134, 0xbfb8aa3b, v134
    v_mul_f32 v135, 0xbfb8aa3b, v135
    v_mul_f32 v136, 0xbfb8aa3b, v136
    v_mul_f32 v137, 0xbfb8aa3b, v137
    v_mul_f32 v138, 0xbfb8aa3b, v138
    v_mul_f32 v139, 0xbfb8aa3b, v139
    v_mul_f32 v140, 0xbfb8aa3b, v140
    v_mul_f32 v141, 0xbfb8aa3b, v141
    v_mul_f32 v142, 0xbfb8aa3b, v142
    v_mul_f32 v143, 0xbfb8aa3b, v143
    v_mul_f32 v144, 0xbfb8aa3b, v144
    v_mul_f32 v145, 0xbfb8aa3b, v145
    v_mul_f32 v146, 0xbfb8aa3b, v146
    v_mul_f32 v147, 0xbfb8aa3b, v147
    v_cvt_pk_bf16_f32 v164, v116, v117
    v_cvt_pk_bf16_f32 v165, v118, v119
    v_cvt_pk_bf16_f32 v166, v120, v121
    v_cvt_pk_bf16_f32 v167, v122, v123
    v_cvt_pk_bf16_f32 v168, v124, v125
    v_cvt_pk_bf16_f32 v169, v126, v127
    v_cvt_pk_bf16_f32 v170, v128, v129
    v_cvt_pk_bf16_f32 v171, v130, v131
    v_cvt_pk_bf16_f32 v172, v132, v133
    v_cvt_pk_bf16_f32 v173, v134, v135
    v_cvt_pk_bf16_f32 v174, v136, v137
    v_cvt_pk_bf16_f32 v175, v138, v139
    v_cvt_pk_bf16_f32 v176, v140, v141
    v_cvt_pk_bf16_f32 v177, v142, v143
    v_cvt_pk_bf16_f32 v178, v144, v145
    v_cvt_pk_bf16_f32 v179, v146, v147
    buffer_store_dwordx4 v[164:167], v[210:211], s[28:31], 0 idxen offen offset:0 sc1
    buffer_store_dwordx4 v[168:171], v[210:211], s[28:31], 0 idxen offen offset:16 sc1
    buffer_store_dwordx4 v[172:175], v[210:211], s[28:31], 0 idxen offen offset:64 sc1
    buffer_store_dwordx4 v[176:179], v[210:211], s[28:31], 0 idxen offen offset:80 sc1
    s_add_u32 s84, s84, 8
    s_cmp_lt_u32 s84, 313
    s_cbranch_scc1 L_tab
    s_waitcnt vmcnt(0)
    s_barrier
L_havetab:
    s_mov_b32 s82, 0
L_scan:
    s_lshl_b32 s64, s86, 2
    v_lshl_add_u32 v231, v1, 4, s64
    global_load_dwordx4 v[148:151], v231, s[12:13]
    global_load_dwordx4 v[152:155], v231, s[10:11]
    v_lshlrev_b32 v231, 4, v231
    s_waitcnt vmcnt(0)
    v_subrev_u32 v232, s27, v148
    v_cmp_gt_u32 vcc, s88, v232
    v_add3_u32 v224, v231, v232, 1
    v_mov_b32 v225, v152
    v_mbcnt_lo_u32_b32 v233, vcc_lo, 0
    v_mbcnt_hi_u32_b32 v233, vcc_hi, v233
    v_add_u32 v233, s82, v233
    v_lshl_add_u32 v233, v233, 3, s81
    s_bcnt1_i32_b64 s64, vcc
    s_add_u32 s82, s82, s64
    s_mov_b64 exec, vcc
    ds_write_b64 v233, v[224:225]
    s_mov_b64 exec, -1
    v_add_u32 v231, 64, v231
    v_subrev_u32 v232, s27, v149
    v_cmp_gt_u32 vcc, s88, v232
    v_add3_u32 v224, v231, v232, 1
    v_mov_b32 v225, v153
    v_mbcnt_lo_u32_b32 v233, vcc_lo, 0
    v_mbcnt_hi_u32_b32 v233, vcc_hi, v233
    v_add_u32 v233, s82, v233
    v_lshl_add_u32 v233, v233, 3, s81
    s_bcnt1_i32_b64 s64, vcc
    s_add_u32 s82, s82, s64
    s_mov_b64 exec, vcc
    ds_write_b64 v233, v[224:225]
    s_mov_b64 exec, -1
    v_add_u32 v231, 64, v231
    v_subrev_u32 v232, s27, v150
    v_cmp_gt_u32 vcc, s88, v232
    v_add3_u32 v224, v231, v232, 1
    v_mov_b32 v225, v154
    v_mbcnt_lo_u32_b32 v233, vcc_lo, 0
    v_mbcnt_hi_u32_b32 v233, vcc_hi, v233
    v_add_u32 v233, s82, v233
    v_lshl_add_u32 v233, v233, 3, s81
    s_bcnt1_i32_b64 s64, vcc
    s_add_u32 s82, s82, s64
    s_mov_b64 exec, vcc
    ds_write_b64 v233, v[224:225]
    s_mov_b64 exec, -1
    v_add_u32 v231, 64, v231
    v_subrev_u32 v232, s27, v151
    v_cmp_gt_u32 vcc, s88, v232
    v_add3_u32 v224, v231, v232, 1
    v_mov_b32 v225, v155
    v_mbcnt_lo_u32_b32 v233, vcc_lo, 0
    v_mbcnt_hi_u32_b32 v233, vcc_hi, v233
    v_add_u32 v233, s82, v233
    v_lshl_add_u32 v233, v233, 3, s81
    s_bcnt1_i32_b64 s64, vcc
    s_add_u32 s82, s82, s64
    s_mov_b64 exec, vcc
    ds_write_b64 v233, v[224:225]
    s_mov_b64 exec, -1
    v_add_u32 v231, 64, v231
    s_add_u32 s86, s86, 256
    s_cmp_ge_u32 s86, 640000
    s_cbranch_scc1 L_round
    s_cmp_le_u32 s82, 160
    s_cbranch_scc1 L_scan
    s_branch L_round
.section .rodata,"a"
.p2align 6
.amdhsa_kernel standalone__cheap_equivariant_egnn__graph_kernel
  .amdhsa_next_free_vgpr 256
  .amdhsa_next_free_sgpr 102
  .amdhsa_accum_offset 256
  .amdhsa_group_segment_fixed_size 0
  .amdhsa_kernarg_size 88
  .amdhsa_user_sgpr_count 2
  .amdhsa_user_sgpr_kernarg_segment_ptr 1
  .amdhsa_system_sgpr_workgroup_id_x 1
  .amdhsa_float_denorm_mode_32 3
.end_amdhsa_kernel
```
